```python
import torch

def _softmax(x, axis=-1):
    return torch.softmax(x, dim=axis)
def _gelu(x):
    return torch.nn.functional.gelu(x, approximate="tanh")
def _silu(x):
    return torch.nn.functional.silu(x)
def _sigmoid(x):
    return torch.sigmoid(x)
def _layernorm(x, axis=-1, eps=1e-5):
    m = x.mean(dim=axis, keepdim=True)
    v = x.var(dim=axis, keepdim=True, unbiased=False)
    return (x - m) / torch.sqrt(v + eps)
def _scatter_add(tgt, idx, src, axis=0):
    return tgt.clone().index_add_(axis, idx, src)
def _segment_sum(src, seg, n):
    out = torch.zeros((n,) + src.shape[1:], dtype=src.dtype)
    return out.index_add_(0, seg, src)
def _pad(x, pw):
    flat = tuple(v for pair in reversed(pw) for v in pair)
    return torch.nn.functional.pad(x, flat)

kernel_name = 'parallel_sum__mha_block__swiglu_ffn__prompt'

def setup_inputs():

    _w = (lambda a: (lambda t: t.to(torch.bfloat16) if t.is_floating_point() else t)(torch.as_tensor(a)))
    def _A_setup():
        B, S, D, H = 1, 2048, 512, 32
        return {
            "x": _w((lambda *s: torch.randn(*s, dtype=torch.bfloat16) * 0.05)(B, S, D)),
            "wqkv": _w((lambda *s: torch.randn(*s, dtype=torch.bfloat16) * 0.2)(D, 3 * D)),
            "wo": _w((lambda *s: torch.randn(*s, dtype=torch.bfloat16) * 0.1)(D, D)),
        }
    _A_in = _A_setup()

    def _B_setup():
        B, S, D, F = 1, 2048, 512, 1792
        return {
            "x": _w((lambda *s: torch.randn(*s, dtype=torch.bfloat16) * 0.05)(B, S, D)),
            "w_gate": _w((lambda *s: torch.randn(*s, dtype=torch.bfloat16) * 0.1)(D, F)),
            "w_up": _w((lambda *s: torch.randn(*s, dtype=torch.bfloat16) * 0.1)(D, F)),
            "w_down": _w((lambda *s: torch.randn(*s, dtype=torch.bfloat16) * 0.1)(F, D)),
        }
    _B_in = _B_setup()

    return {
        "A_x": _A_in["x"],
        "A_wqkv": _A_in["wqkv"],
        "A_wo": _A_in["wo"],
        "B_x": _B_in["x"],
        "B_w_gate": _B_in["w_gate"],
        "B_w_up": _B_in["w_up"],
        "B_w_down": _B_in["w_down"],
    }

def reference(A_x, A_wqkv, A_wo, B_x, B_w_gate, B_w_up, B_w_down):
    def _A_ref(x, wqkv, wo):
        B, S, D = x.shape
        H = 32
        Dh = D // H
        qkv = (lambda x, *d: x.permute(*d))((x @ wqkv).reshape(B, S, 3, H, Dh), 2, 0, 3, 1, 4)
        q, k, v = qkv[0], qkv[1], qkv[2]
        scores = torch.einsum("bhqd,bhkd->bhqk", q, k) * (Dh ** -0.5)
        p = _softmax(scores, axis=-1)
        o = torch.einsum("bhqk,bhkd->bhqd", p, v)
        return (lambda x, *d: x.permute(*d))(o, 0, 2, 1, 3).reshape(B, S, D) @ wo

    def _B_ref(x, w_gate, w_up, w_down):
        g = _silu(x @ w_gate)
        u = x @ w_up
        return (g * u) @ w_down

    x = A_x
    xn = _layernorm(x, axis=-1)
    return x + _A_ref(xn, A_wqkv, A_wo) + _B_ref(xn, B_w_gate, B_w_up, B_w_down)
```

```asm
; @launch grid=(256,1,1) block=(512,1,1) lds=163840
.amdgcn_target "amdgcn-amd-amdhsa--gfx950"
.text
.globl parallel_sum__mha_block__swiglu_ffn__prompt_kernel
.p2align 8
.type parallel_sum__mha_block__swiglu_ffn__prompt_kernel,@function
parallel_sum__mha_block__swiglu_ffn__prompt_kernel:
    s_cmp_ge_u32 s2, 256
    s_cbranch_scc1 parallel_sum__mha_block__swiglu_ffn__prompt_kernel_end
    s_setprio 1
    s_load_dwordx16 s[64:79], s[0:1], 0
    s_load_dwordx4 s[80:83], s[0:1], 64
    v_lshrrev_b32 v1, 6, v0
    v_and_b32 v0, 63, v0
    v_readfirstlane_b32 s24, v1
    s_getpc_b64 s[34:35]
parallel_sum__mha_block__swiglu_ffn__prompt_kernel_pc:
    s_sub_u32 s34, s34, parallel_sum__mha_block__swiglu_ffn__prompt_kernel_pc-parallel_sum__mha_block__swiglu_ffn__prompt_kernel
    s_subb_u32 s35, s35, 0
    s_and_b32 s36, s2, 0x18
    s_add_u32 s36, s36, s24
    s_lshl_b32 s36, s36, 10
    s_min_u32 s36, s36, parallel_sum__mha_block__swiglu_ffn__prompt_kernel_last-parallel_sum__mha_block__swiglu_ffn__prompt_kernel-1024
    v_lshlrev_b32 v2, 4, v0
    v_add_u32 v2, s36, v2
    global_load_dwordx4 v[96:99], v2, s[34:35]
    s_and_b32 s34, s2, 7
    s_lshr_b32 s35, s2, 3
    s_and_b32 s25, s34, 1
    s_lshl_b32 s25, s25, 3
    s_and_b32 s36, s35, 7
    s_add_u32 s25, s25, s36
    s_lshr_b32 s26, s34, 1
    s_lshl_b32 s26, s26, 2
    s_lshr_b32 s36, s35, 3
    s_add_u32 s26, s26, s36
    s_lshl_b32 s27, s25, 2
    s_and_b32 s36, s24, 3
    s_add_u32 s27, s27, s36
    s_lshr_b32 s49, s24, 2
    s_mov_b32 s39, s49
    v_lshlrev_b32 v1, 4, v0
    v_lshrrev_b32 v3, 5, v0
    v_lshlrev_b32 v3, 3, v3
    v_bfe_u32 v5, v0, 2, 2
    v_add_u32 v3, v3, v5
    v_lshlrev_b32 v3, 7, v3
    v_bfe_u32 v5, v0, 4, 1
    v_lshl_add_u32 v3, v5, 5, v3
    v_and_b32 v5, 3, v0
    v_lshl_add_u32 v3, v5, 3, v3
    v_bfe_u32 v5, v0, 3, 1
    v_lshl_add_u32 v3, v5, 6, v3
    s_lshl_b32 s36, s49, 6
    v_xor_b32 v3, s36, v3
    v_add_u32 v3, 98304, v3
    v_lshrrev_b32 v6, 3, v0
    v_bfe_u32 v7, v0, 4, 1
    v_lshlrev_b32 v7, 2, v7
    v_and_b32 v5, 7, v0
    v_xor_b32 v7, v7, v5
    v_lshlrev_b32 v7, 4, v7
    s_lshl_b32 s33, s24, 11
    s_add_u32 s33, s33, 98304
    s_mul_i32 s40, s26, 34082946
    s_add_u32 s40, s40, 17039360
    s_mul_i32 s41, s26, 17047681
    s_add_u32 s41, s41, 204443136
    s_mov_b32 s42, 910
    s_cmp_ge_u32 s26, 12
    s_cselect_b32 s63, s41, s40
    s_cselect_b32 s62, 916, s42
    v_mov_b32 v101, 0
    s_mov_b32 s60, 20987904
    s_lshl_b32 s56, s25, 17
    s_lshl_b32 s57, s24, 14
    s_add_u32 s56, s56, s57
    s_mov_b32 s28, 0
    s_lshl_b32 s40, s28, 1
    s_mul_i32 s41, s28, 6
    s_lshr_b32 s29, s62, s40
    s_lshr_b32 s30, s63, s41
    s_and_b32 s29, s29, 3
    s_and_b32 s30, s30, 63
    s_waitcnt lgkmcnt(0)
    s_mov_b32 s12, s82
    s_mov_b32 s13, s83
    s_mov_b32 s14, 21004288
    s_mov_b32 s15, 0x00020000
    s_mov_b32 s20, s64
    s_mov_b32 s21, s65
    s_mov_b32 s22, 2097152
    s_mov_b32 s23, 0x00020000
    s_mov_b32 s19, 0x00020000
    s_bitcmp1_b32 s24, 0
    s_cselect_b32 s8, s74, s72
    s_cselect_b32 s9, s75, s73
    v_xor_b32 v110, 0, v1
    s_add_u32 m0, s57, 0
    s_add_u32 s58, s56, 0
    buffer_load_dwordx4 v110, s[20:23], s58 offen lds
    v_xor_b32 v111, 16, v1
    s_add_u32 m0, s57, 1024
    s_add_u32 s58, s56, 1024
    buffer_load_dwordx4 v111, s[20:23], s58 offen lds
    v_xor_b32 v110, 32, v1
    s_add_u32 m0, s57, 2048
    s_add_u32 s58, s56, 2048
    buffer_load_dwordx4 v110, s[20:23], s58 offen lds
    v_xor_b32 v111, 48, v1
    s_add_u32 m0, s57, 3072
    s_add_u32 s58, s56, 3072
    buffer_load_dwordx4 v111, s[20:23], s58 offen lds
    v_xor_b32 v110, 64, v1
    s_add_u32 m0, s57, 4096
    s_add_u32 s58, s56, 4096
    buffer_load_dwordx4 v110, s[20:23], s58 offen lds
    v_xor_b32 v111, 80, v1
    s_add_u32 m0, s57, 5120
    s_add_u32 s58, s56, 5120
    buffer_load_dwordx4 v111, s[20:23], s58 offen lds
    v_xor_b32 v110, 96, v1
    s_add_u32 m0, s57, 6144
    s_add_u32 s58, s56, 6144
    buffer_load_dwordx4 v110, s[20:23], s58 offen lds
    v_xor_b32 v111, 112, v1
    s_add_u32 m0, s57, 7168
    s_add_u32 s58, s56, 7168
    buffer_load_dwordx4 v111, s[20:23], s58 offen lds
    s_setprio 0
    buffer_load_dword v100, v101, s[12:15], s60 offen sc0 sc1
    v_and_b32 v102, 7, v0
    v_lshrrev_b32 v103, 3, v0
    v_lshlrev_b32 v104, 1, v102
    v_xor_b32 v104, v104, v103
    v_lshlrev_b32 v104, 4, v104
    v_lshl_add_u32 v104, v102, 10, v104
    v_add_u32 v104, s57, v104
    v_xor_b32 v105, 128, v104
    s_mov_b32 s61, 0xffff0000
    v_xor_b32 v110, 128, v1
    s_add_u32 m0, s57, 8192
    s_add_u32 s58, s56, 8192
    buffer_load_dwordx4 v110, s[20:23], s58 offen lds
    v_xor_b32 v111, 144, v1
    s_add_u32 m0, s57, 9216
    s_add_u32 s58, s56, 9216
    buffer_load_dwordx4 v111, s[20:23], s58 offen lds
    v_xor_b32 v110, 160, v1
    s_add_u32 m0, s57, 10240
    s_add_u32 s58, s56, 10240
    buffer_load_dwordx4 v110, s[20:23], s58 offen lds
    v_xor_b32 v111, 176, v1
    s_add_u32 m0, s57, 11264
    s_add_u32 s58, s56, 11264
    buffer_load_dwordx4 v111, s[20:23], s58 offen lds
    v_xor_b32 v110, 192, v1
    s_add_u32 m0, s57, 12288
    s_add_u32 s58, s56, 12288
    buffer_load_dwordx4 v110, s[20:23], s58 offen lds
    v_xor_b32 v111, 208, v1
    s_add_u32 m0, s57, 13312
    s_add_u32 s58, s56, 13312
    buffer_load_dwordx4 v111, s[20:23], s58 offen lds
    v_xor_b32 v110, 224, v1
    s_add_u32 m0, s57, 14336
    s_add_u32 s58, s56, 14336
    buffer_load_dwordx4 v110, s[20:23], s58 offen lds
    v_xor_b32 v111, 240, v1
    s_add_u32 m0, s57, 15360
    s_add_u32 s58, s56, 15360
    buffer_load_dwordx4 v111, s[20:23], s58 offen lds
    s_mov_b32 s47, 0
    s_waitcnt vmcnt(9)
parallel_sum__mha_block__swiglu_ffn__prompt_kernel_ln:
    ds_read_b128 v[8:11], v104 offset:0
    ds_read_b128 v[12:15], v105 offset:0
    ds_read_b128 v[16:19], v104 offset:256
    ds_read_b128 v[20:23], v105 offset:256
    ds_read_b128 v[24:27], v104 offset:512
    ds_read_b128 v[28:31], v105 offset:512
    ds_read_b128 v[32:35], v104 offset:768
    ds_read_b128 v[36:39], v105 offset:768
    s_waitcnt lgkmcnt(7)
    v_lshlrev_b32 v128, 16, v8
    v_and_b32 v129, s61, v8
    v_lshlrev_b32 v130, 16, v9
    v_and_b32 v131, s61, v9
    v_lshlrev_b32 v132, 16, v10
    v_and_b32 v133, s61, v10
    v_lshlrev_b32 v134, 16, v11
    v_and_b32 v135, s61, v11
    v_pk_mul_f32 v[64:65], v[128:129], v[128:129]
    v_pk_mul_f32 v[66:67], v[130:131], v[130:131]
    v_pk_mul_f32 v[68:69], v[132:133], v[132:133]
    v_pk_mul_f32 v[70:71], v[134:135], v[134:135]
    s_waitcnt lgkmcnt(6)
    v_lshlrev_b32 v136, 16, v12
    v_and_b32 v137, s61, v12
    v_lshlrev_b32 v138, 16, v13
    v_and_b32 v139, s61, v13
    v_lshlrev_b32 v140, 16, v14
    v_and_b32 v141, s61, v14
    v_lshlrev_b32 v142, 16, v15
    v_and_b32 v143, s61, v15
    v_pk_fma_f32 v[64:65], v[136:137], v[136:137], v[64:65]
    v_pk_fma_f32 v[66:67], v[138:139], v[138:139], v[66:67]
    v_pk_fma_f32 v[68:69], v[140:141], v[140:141], v[68:69]
    v_pk_fma_f32 v[70:71], v[142:143], v[142:143], v[70:71]
    v_pk_add_f32 v[40:41], v[128:129], v[136:137]
    v_pk_add_f32 v[42:43], v[130:131], v[138:139]
    v_pk_add_f32 v[44:45], v[132:133], v[140:141]
    v_pk_add_f32 v[46:47], v[134:135], v[142:143]
    s_waitcnt lgkmcnt(5)
    v_lshlrev_b32 v144, 16, v16
    v_and_b32 v145, s61, v16
    v_lshlrev_b32 v146, 16, v17
    v_and_b32 v147, s61, v17
    v_lshlrev_b32 v148, 16, v18
    v_and_b32 v149, s61, v18
    v_lshlrev_b32 v150, 16, v19
    v_and_b32 v151, s61, v19
    v_pk_fma_f32 v[64:65], v[144:145], v[144:145], v[64:65]
    v_pk_fma_f32 v[66:67], v[146:147], v[146:147], v[66:67]
    v_pk_fma_f32 v[68:69], v[148:149], v[148:149], v[68:69]
    v_pk_fma_f32 v[70:71], v[150:151], v[150:151], v[70:71]
    v_pk_add_f32 v[40:41], v[40:41], v[144:145]
    v_pk_add_f32 v[42:43], v[42:43], v[146:147]
    v_pk_add_f32 v[44:45], v[44:45], v[148:149]
    v_pk_add_f32 v[46:47], v[46:47], v[150:151]
    s_waitcnt lgkmcnt(4)
    v_lshlrev_b32 v152, 16, v20
    v_and_b32 v153, s61, v20
    v_lshlrev_b32 v154, 16, v21
    v_and_b32 v155, s61, v21
    v_lshlrev_b32 v156, 16, v22
    v_and_b32 v157, s61, v22
    v_lshlrev_b32 v158, 16, v23
    v_and_b32 v159, s61, v23
    v_pk_fma_f32 v[64:65], v[152:153], v[152:153], v[64:65]
    v_pk_fma_f32 v[66:67], v[154:155], v[154:155], v[66:67]
    v_pk_fma_f32 v[68:69], v[156:157], v[156:157], v[68:69]
    v_pk_fma_f32 v[70:71], v[158:159], v[158:159], v[70:71]
    v_pk_add_f32 v[40:41], v[40:41], v[152:153]
    v_pk_add_f32 v[42:43], v[42:43], v[154:155]
    v_pk_add_f32 v[44:45], v[44:45], v[156:157]
    v_pk_add_f32 v[46:47], v[46:47], v[158:159]
    s_waitcnt lgkmcnt(3)
    v_lshlrev_b32 v160, 16, v24
    v_and_b32 v161, s61, v24
    v_lshlrev_b32 v162, 16, v25
    v_and_b32 v163, s61, v25
    v_lshlrev_b32 v164, 16, v26
    v_and_b32 v165, s61, v26
    v_lshlrev_b32 v166, 16, v27
    v_and_b32 v167, s61, v27
    v_pk_fma_f32 v[64:65], v[160:161], v[160:161], v[64:65]
    v_pk_fma_f32 v[66:67], v[162:163], v[162:163], v[66:67]
    v_pk_fma_f32 v[68:69], v[164:165], v[164:165], v[68:69]
    v_pk_fma_f32 v[70:71], v[166:167], v[166:167], v[70:71]
    v_pk_add_f32 v[40:41], v[40:41], v[160:161]
    v_pk_add_f32 v[42:43], v[42:43], v[162:163]
    v_pk_add_f32 v[44:45], v[44:45], v[164:165]
    v_pk_add_f32 v[46:47], v[46:47], v[166:167]
    s_waitcnt lgkmcnt(2)
    v_lshlrev_b32 v168, 16, v28
    v_and_b32 v169, s61, v28
    v_lshlrev_b32 v170, 16, v29
    v_and_b32 v171, s61, v29
    v_lshlrev_b32 v172, 16, v30
    v_and_b32 v173, s61, v30
    v_lshlrev_b32 v174, 16, v31
    v_and_b32 v175, s61, v31
    v_pk_fma_f32 v[64:65], v[168:169], v[168:169], v[64:65]
    v_pk_fma_f32 v[66:67], v[170:171], v[170:171], v[66:67]
    v_pk_fma_f32 v[68:69], v[172:173], v[172:173], v[68:69]
    v_pk_fma_f32 v[70:71], v[174:175], v[174:175], v[70:71]
    v_pk_add_f32 v[40:41], v[40:41], v[168:169]
    v_pk_add_f32 v[42:43], v[42:43], v[170:171]
    v_pk_add_f32 v[44:45], v[44:45], v[172:173]
    v_pk_add_f32 v[46:47], v[46:47], v[174:175]
    s_waitcnt lgkmcnt(1)
    v_lshlrev_b32 v176, 16, v32
    v_and_b32 v177, s61, v32
    v_lshlrev_b32 v178, 16, v33
    v_and_b32 v179, s61, v33
    v_lshlrev_b32 v180, 16, v34
    v_and_b32 v181, s61, v34
    v_lshlrev_b32 v182, 16, v35
    v_and_b32 v183, s61, v35
    v_pk_fma_f32 v[64:65], v[176:177], v[176:177], v[64:65]
    v_pk_fma_f32 v[66:67], v[178:179], v[178:179], v[66:67]
    v_pk_fma_f32 v[68:69], v[180:181], v[180:181], v[68:69]
    v_pk_fma_f32 v[70:71], v[182:183], v[182:183], v[70:71]
    v_pk_add_f32 v[40:41], v[40:41], v[176:177]
    v_pk_add_f32 v[42:43], v[42:43], v[178:179]
    v_pk_add_f32 v[44:45], v[44:45], v[180:181]
    v_pk_add_f32 v[46:47], v[46:47], v[182:183]
    s_waitcnt lgkmcnt(0)
    v_lshlrev_b32 v184, 16, v36
    v_and_b32 v185, s61, v36
    v_lshlrev_b32 v186, 16, v37
    v_and_b32 v187, s61, v37
    v_lshlrev_b32 v188, 16, v38
    v_and_b32 v189, s61, v38
    v_lshlrev_b32 v190, 16, v39
    v_and_b32 v191, s61, v39
    v_pk_fma_f32 v[64:65], v[184:185], v[184:185], v[64:65]
    v_pk_fma_f32 v[66:67], v[186:187], v[186:187], v[66:67]
    v_pk_fma_f32 v[68:69], v[188:189], v[188:189], v[68:69]
    v_pk_fma_f32 v[70:71], v[190:191], v[190:191], v[70:71]
    v_pk_add_f32 v[40:41], v[40:41], v[184:185]
    v_pk_add_f32 v[42:43], v[42:43], v[186:187]
    v_pk_add_f32 v[44:45], v[44:45], v[188:189]
    v_pk_add_f32 v[46:47], v[46:47], v[190:191]
    v_pk_add_f32 v[40:41], v[40:41], v[42:43]
    v_pk_add_f32 v[64:65], v[64:65], v[66:67]
    v_pk_add_f32 v[44:45], v[44:45], v[46:47]
    v_pk_add_f32 v[68:69], v[68:69], v[70:71]
    v_pk_add_f32 v[40:41], v[40:41], v[44:45]
    v_pk_add_f32 v[64:65], v[64:65], v[68:69]
    v_add_f32 v48, v40, v41
    v_add_f32 v52, v64, v65
    s_nop 0
    v_add_f32_dpp v48, v48, v48 row_ror:8 row_mask:0xf bank_mask:0xf
    v_add_f32_dpp v52, v52, v52 row_ror:8 row_mask:0xf bank_mask:0xf
    v_mov_b32 v50, v48
    v_mov_b32 v51, v48
    v_mov_b32 v54, v52
    v_mov_b32 v55, v52
    v_permlane16_swap_b32 v50, v51
    s_nop 0
    v_permlane16_swap_b32 v54, v55
    v_add_f32 v48, v50, v51
    v_add_f32 v52, v54, v55
    v_mov_b32 v50, v48
    v_mov_b32 v51, v48
    v_mov_b32 v54, v52
    v_mov_b32 v55, v52
    v_permlane32_swap_b32 v50, v51
    s_nop 0
    v_permlane32_swap_b32 v54, v55
    v_add_f32 v48, v50, v51
    v_add_f32 v52, v54, v55
    v_mul_f32 v48, 989855744, v48
    v_mov_b32 v49, 925353388
    v_fmac_f32 v49, 989855744, v52
    v_fma_f32 v49, -v48, v48, v49
    v_max_f32 v49, 925353388, v49
    v_rsq_f32 v50, v49
    s_nop 0
    v_mov_b32 v51, v50
    v_mul_f32_e64 v52, -v48, v50
    v_mov_b32 v53, v52
    v_pk_fma_f32 v[128:129], v[128:129], v[50:51], v[52:53]
    v_pk_fma_f32 v[130:131], v[130:131], v[50:51], v[52:53]
    v_pk_fma_f32 v[132:133], v[132:133], v[50:51], v[52:53]
    v_pk_fma_f32 v[134:135], v[134:135], v[50:51], v[52:53]
    v_cvt_pk_bf16_f32 v8, v128, v129
    v_cvt_pk_bf16_f32 v9, v130, v131
    v_cvt_pk_bf16_f32 v10, v132, v133
    v_cvt_pk_bf16_f32 v11, v134, v135
    ds_write_b128 v104, v[8:11] offset:0
    v_pk_fma_f32 v[136:137], v[136:137], v[50:51], v[52:53]
    v_pk_fma_f32 v[138:139], v[138:139], v[50:51], v[52:53]
    v_pk_fma_f32 v[140:141], v[140:141], v[50:51], v[52:53]
    v_pk_fma_f32 v[142:143], v[142:143], v[50:51], v[52:53]
    v_cvt_pk_bf16_f32 v12, v136, v137
    v_cvt_pk_bf16_f32 v13, v138, v139
    v_cvt_pk_bf16_f32 v14, v140, v141
    v_cvt_pk_bf16_f32 v15, v142, v143
    ds_write_b128 v105, v[12:15] offset:0
    v_pk_fma_f32 v[144:145], v[144:145], v[50:51], v[52:53]
    v_pk_fma_f32 v[146:147], v[146:147], v[50:51], v[52:53]
    v_pk_fma_f32 v[148:149], v[148:149], v[50:51], v[52:53]
    v_pk_fma_f32 v[150:151], v[150:151], v[50:51], v[52:53]
    v_cvt_pk_bf16_f32 v16, v144, v145
    v_cvt_pk_bf16_f32 v17, v146, v147
    v_cvt_pk_bf16_f32 v18, v148, v149
    v_cvt_pk_bf16_f32 v19, v150, v151
    ds_write_b128 v104, v[16:19] offset:256
    v_pk_fma_f32 v[152:153], v[152:153], v[50:51], v[52:53]
    v_pk_fma_f32 v[154:155], v[154:155], v[50:51], v[52:53]
    v_pk_fma_f32 v[156:157], v[156:157], v[50:51], v[52:53]
    v_pk_fma_f32 v[158:159], v[158:159], v[50:51], v[52:53]
    v_cvt_pk_bf16_f32 v20, v152, v153
    v_cvt_pk_bf16_f32 v21, v154, v155
    v_cvt_pk_bf16_f32 v22, v156, v157
    v_cvt_pk_bf16_f32 v23, v158, v159
    ds_write_b128 v105, v[20:23] offset:256
    v_pk_fma_f32 v[160:161], v[160:161], v[50:51], v[52:53]
    v_pk_fma_f32 v[162:163], v[162:163], v[50:51], v[52:53]
    v_pk_fma_f32 v[164:165], v[164:165], v[50:51], v[52:53]
    v_pk_fma_f32 v[166:167], v[166:167], v[50:51], v[52:53]
    v_cvt_pk_bf16_f32 v24, v160, v161
    v_cvt_pk_bf16_f32 v25, v162, v163
    v_cvt_pk_bf16_f32 v26, v164, v165
    v_cvt_pk_bf16_f32 v27, v166, v167
    ds_write_b128 v104, v[24:27] offset:512
    v_pk_fma_f32 v[168:169], v[168:169], v[50:51], v[52:53]
    v_pk_fma_f32 v[170:171], v[170:171], v[50:51], v[52:53]
    v_pk_fma_f32 v[172:173], v[172:173], v[50:51], v[52:53]
    v_pk_fma_f32 v[174:175], v[174:175], v[50:51], v[52:53]
    v_cvt_pk_bf16_f32 v28, v168, v169
    v_cvt_pk_bf16_f32 v29, v170, v171
    v_cvt_pk_bf16_f32 v30, v172, v173
    v_cvt_pk_bf16_f32 v31, v174, v175
    ds_write_b128 v105, v[28:31] offset:512
    v_pk_fma_f32 v[176:177], v[176:177], v[50:51], v[52:53]
    v_pk_fma_f32 v[178:179], v[178:179], v[50:51], v[52:53]
    v_pk_fma_f32 v[180:181], v[180:181], v[50:51], v[52:53]
    v_pk_fma_f32 v[182:183], v[182:183], v[50:51], v[52:53]
    v_cvt_pk_bf16_f32 v32, v176, v177
    v_cvt_pk_bf16_f32 v33, v178, v179
    v_cvt_pk_bf16_f32 v34, v180, v181
    v_cvt_pk_bf16_f32 v35, v182, v183
    ds_write_b128 v104, v[32:35] offset:768
    v_pk_fma_f32 v[184:185], v[184:185], v[50:51], v[52:53]
    v_pk_fma_f32 v[186:187], v[186:187], v[50:51], v[52:53]
    v_pk_fma_f32 v[188:189], v[188:189], v[50:51], v[52:53]
    v_pk_fma_f32 v[190:191], v[190:191], v[50:51], v[52:53]
    v_cvt_pk_bf16_f32 v36, v184, v185
    v_cvt_pk_bf16_f32 v37, v186, v187
    v_cvt_pk_bf16_f32 v38, v188, v189
    v_cvt_pk_bf16_f32 v39, v190, v191
    ds_write_b128 v105, v[36:39] offset:768
    v_add_u32 v104, 8192, v104
    v_add_u32 v105, 8192, v105
    s_cmp_lg_u32 s47, 0
    s_cbranch_scc1 parallel_sum__mha_block__swiglu_ffn__prompt_kernel_ln_done
    s_mov_b32 s47, 1
    s_lshl_b32 s42, s30, 7
    s_and_b32 s40, s29, 1
    s_lshl_b32 s40, s40, 8
    s_lshr_b32 s41, s24, 1
    s_lshl_b32 s41, s41, 4
    s_add_u32 s40, s40, s41
    s_lshl_b32 s41, s24, 4
    s_cmp_lt_u32 s29, 2
    s_cselect_b32 s16, s66, s8
    s_cselect_b32 s17, s67, s9
    s_cselect_b32 s31, 6, 7
    s_cselect_b32 s32, s41, s40
    s_cselect_b32 s45, 128, 64
    s_lshl_b32 s31, s31, 9
    s_add_u32 s16, s16, s42
    s_addc_u32 s17, s17, 0
    s_lshl_b32 s18, s31, 9
    s_sub_u32 s18, s18, s42
    s_mul_i32 s32, s32, s31
    s_mul_i32 s45, s45, s31
    s_lshl_b32 s44, s31, 3
    v_mad_u32_u24 v2, v6, s31, v7
    s_mov_b32 s59, s32
    s_lshl_b32 s40, s45, 1
    s_add_u32 s32, s32, s40
    s_add_u32 m0, s33, 32768
    s_nop 0
    buffer_load_dwordx4 v2, s[16:19], s32 offen lds
    s_add_u32 m0, s33, 33792
    s_add_u32 s46, s32, s44
    buffer_load_dwordx4 v2, s[16:19], s46 offen lds
    s_add_u32 s32, s32, s45
    s_add_u32 m0, s33, 49152
    s_nop 0
    buffer_load_dwordx4 v2, s[16:19], s32 offen lds
    s_add_u32 m0, s33, 50176
    s_add_u32 s46, s32, s44
    buffer_load_dwordx4 v2, s[16:19], s46 offen lds
    s_add_u32 s32, s32, s45
    s_mov_b32 s48, 1
    s_lshl_b32 s40, s48, 1
    s_mul_i32 s41, s48, 6
    s_lshr_b32 s52, s62, s40
    s_lshr_b32 s53, s63, s41
    s_and_b32 s52, s52, 3
    s_and_b32 s53, s53, 63
    s_and_b32 s40, s25, 7
    s_lshl_b32 s40, s40, 6
    s_lshl_b32 s41, s24, 3
    s_add_u32 s40, s40, s41
    v_add_u32 v106, s40, v6
    v_and_b32 v107, 7, v0
    v_lshlrev_b32 v107, 4, v107
    s_movk_i32 s41, 3584
    s_movk_i32 s42, 3072
    v_mad_u32_u24 v108, v106, s41, v107
    v_mad_u32_u24 v109, v106, s42, v107
    s_bfe_u32 s40, s63, 0x60018
    s_lshl_b32 s40, s40, 7
    s_bfe_u32 s41, s63, 0x6000c
    s_lshl_b32 s41, s41, 7
    s_cmp_ge_u32 s26, 12
    s_cselect_b32 s43, 6, 7
    s_cselect_b32 s20, s66, s72
    s_cselect_b32 s21, s67, s73
    s_cselect_b32 s34, s66, s74
    s_cselect_b32 s35, s67, s75
    s_lshl_b32 s43, s43, 9
    s_lshl_b32 s22, s43, 9
    v_mad_u32_u24 v110, v106, s43, v107
    s_lshl_b32 s43, s30, 7
    buffer_load_dwordx4 v[96:99], v110, s[20:23], s43 offen
    s_mov_b32 s20, s34
    s_mov_b32 s21, s35
    s_lshl_b32 s43, s53, 7
    buffer_load_dwordx4 v[96:99], v110, s[20:23], s43 offen
    s_mov_b32 s20, s66
    s_mov_b32 s21, s67
    s_mov_b32 s22, 1572864
    s_mov_b32 s23, 0x00020000
    buffer_load_dwordx4 v[96:99], v109, s[20:23], s41 offen
    s_mov_b32 s20, s72
    s_mov_b32 s21, s73
    s_mov_b32 s22, 1835008
    s_mov_b32 s23, 0x00020000
    buffer_load_dwordx4 v[96:99], v108, s[20:23], s40 offen
    s_mov_b32 s20, s74
    s_mov_b32 s21, s75
    s_mov_b32 s22, 1835008
    s_mov_b32 s23, 0x00020000
    buffer_load_dwordx4 v[96:99], v108, s[20:23], s40 offen
    s_waitcnt vmcnt(9)
    s_branch parallel_sum__mha_block__swiglu_ffn__prompt_kernel_ln
parallel_sum__mha_block__swiglu_ffn__prompt_kernel_ln_done:
    v_lshrrev_b32 v102, 5, v0
    v_xor_b32 v102, v102, v0
    v_and_b32 v102, 15, v102
    v_lshlrev_b32 v102, 4, v102
    v_and_b32 v103, 31, v0
    v_lshl_add_u32 v102, v103, 10, v102
    s_and_b32 s40, s24, 3
    s_lshl_b32 s40, s40, 15
    v_add_u32 v102, s40, v102
    v_xor_b32 v103, 32, v102
    v_xor_b32 v104, 64, v102
    v_xor_b32 v105, 96, v102
    v_xor_b32 v106, 128, v102
    v_xor_b32 v107, 160, v102
    v_xor_b32 v108, 192, v102
    v_xor_b32 v109, 224, v102
    s_waitcnt vmcnt(5) lgkmcnt(0)
    v_readfirstlane_b32 s84, v100
    s_nop 3
    s_add_u32 s84, s84, 1
    s_barrier
    ds_read_b128 v[128:131], v102 offset:0
    ds_read_b128 v[132:135], v103 offset:0
    ds_read_b128 v[136:139], v104 offset:0
    ds_read_b128 v[140:143], v105 offset:0
    ds_read_b128 v[144:147], v106 offset:0
    ds_read_b128 v[148:151], v107 offset:0
    ds_read_b128 v[152:155], v108 offset:0
    ds_read_b128 v[156:159], v109 offset:0
    s_waitcnt lgkmcnt(4)
    ds_read_b128 v[160:163], v102 offset:256
    ds_read_b128 v[164:167], v103 offset:256
    ds_read_b128 v[168:171], v104 offset:256
    ds_read_b128 v[172:175], v105 offset:256
    ds_read_b128 v[176:179], v106 offset:256
    ds_read_b128 v[180:183], v107 offset:256
    ds_read_b128 v[184:187], v108 offset:256
    ds_read_b128 v[188:191], v109 offset:256
    s_waitcnt lgkmcnt(4)
    ds_read_b128 v[192:195], v102 offset:512
    ds_read_b128 v[196:199], v103 offset:512
    ds_read_b128 v[200:203], v104 offset:512
    ds_read_b128 v[204:207], v105 offset:512
    ds_read_b128 v[208:211], v106 offset:512
    ds_read_b128 v[212:215], v107 offset:512
    ds_read_b128 v[216:219], v108 offset:512
    ds_read_b128 v[220:223], v109 offset:512
    s_waitcnt lgkmcnt(4)
    ds_read_b128 v[224:227], v102 offset:768
    ds_read_b128 v[228:231], v103 offset:768
    ds_read_b128 v[232:235], v104 offset:768
    ds_read_b128 v[236:239], v105 offset:768
    ds_read_b128 v[240:243], v106 offset:768
    ds_read_b128 v[244:247], v107 offset:768
    ds_read_b128 v[248:251], v108 offset:768
    ds_read_b128 v[252:255], v109 offset:768
    v_and_b32 v112, 11, v0
    v_cmp_eq_u32 vcc, 0, v112
    v_mov_b32 v113, 0x3f803f80
    v_lshrrev_b32 v116, 4, v0
    v_cndmask_b32 v112, 0, v113, vcc
    v_lshlrev_b32 v116, 9, v116
    v_and_b32 v117, 15, v0
    v_lshl_add_u32 v116, v117, 4, v116
    v_mov_b32 v113, v112
    v_mov_b32 v114, v112
    v_mov_b32 v115, v112
    s_and_b32 s40, s26, 7
    s_lshl_b32 s40, s40, 2
    s_lshr_b32 s41, s26, 3
    s_lshl_b32 s41, s41, 1
    s_add_u32 s40, s40, s41
    s_add_u32 s40, s40, s49
    s_lshl_b32 s40, s40, 17
    s_lshl_b32 s41, s27, 11
    s_add_u32 s40, s40, s41
    s_add_u32 s40, s40, 6291712
    buffer_store_dwordx4 v[112:115], v116, s[12:15], s40 offen sc0 sc1
    s_lshl_b32 s42, s30, 7
    s_and_b32 s40, s29, 1
    s_lshl_b32 s40, s40, 8
    s_lshr_b32 s41, s24, 1
    s_lshl_b32 s41, s41, 4
    s_add_u32 s40, s40, s41
    s_lshl_b32 s41, s24, 4
    s_cmp_lt_u32 s29, 2
    s_cselect_b32 s16, s66, s8
    s_cselect_b32 s17, s67, s9
    s_cselect_b32 s31, 6, 7
    s_cselect_b32 s32, s41, s40
    s_cselect_b32 s45, 128, 64
    s_lshl_b32 s31, s31, 9
    s_add_u32 s16, s16, s42
    s_addc_u32 s17, s17, 0
    s_lshl_b32 s18, s31, 9
    s_sub_u32 s18, s18, s42
    s_mul_i32 s32, s32, s31
    s_mul_i32 s45, s45, s31
    s_lshl_b32 s44, s31, 3
    v_mad_u32_u24 v2, v6, s31, v7
    s_waitcnt lgkmcnt(0)
    ds_read_b64_tr_b16 v[8:9], v3 offset:32768
    ds_read_b64_tr_b16 v[10:11], v3 offset:33280
    ds_read_b64_tr_b16 v[12:13], v3 offset:34816
    ds_read_b64_tr_b16 v[14:15], v3 offset:35328
    ds_read_b64_tr_b16 v[16:17], v3 offset:36864
    ds_read_b64_tr_b16 v[18:19], v3 offset:37376
    s_barrier
    s_add_u32 m0, s33, 0
    s_nop 0
    buffer_load_dwordx4 v2, s[16:19], s32 offen lds
    s_add_u32 m0, s33, 1024
    s_add_u32 s46, s32, s44
    buffer_load_dwordx4 v2, s[16:19], s46 offen lds
    s_add_u32 s32, s32, s45
    s_add_u32 m0, s33, 16384
    s_nop 0
    buffer_load_dwordx4 v2, s[16:19], s32 offen lds
    s_add_u32 m0, s33, 17408
    s_add_u32 s46, s32, s44
    buffer_load_dwordx4 v2, s[16:19], s46 offen lds
    s_add_u32 s32, s32, s45
    s_lshl_b32 s42, s53, 7
    s_and_b32 s40, s52, 1
    s_lshl_b32 s40, s40, 8
    s_lshr_b32 s41, s24, 1
    s_lshl_b32 s41, s41, 4
    s_add_u32 s40, s40, s41
    s_lshl_b32 s41, s24, 4
    s_cmp_lt_u32 s52, 2
    s_cselect_b32 s16, s66, s8
    s_cselect_b32 s17, s67, s9
    s_cselect_b32 s31, 6, 7
    s_cselect_b32 s32, s41, s40
    s_cselect_b32 s45, 128, 64
    s_lshl_b32 s31, s31, 9
    s_add_u32 s16, s16, s42
    s_addc_u32 s17, s17, 0
    s_lshl_b32 s18, s31, 9
    s_sub_u32 s18, s18, s42
    s_mul_i32 s32, s32, s31
    s_mul_i32 s45, s45, s31
    s_lshl_b32 s44, s31, 3
    v_mad_u32_u24 v2, v6, s31, v7
    s_lshl_b32 s33, s24, 11
    v_bfe_u32 v4, v0, 4, 1
    v_lshlrev_b32 v4, 17, v4
    v_lshrrev_b32 v5, 5, v0
    v_lshl_add_u32 v4, v5, 9, v4
    v_and_b32 v5, 15, v0
    v_lshl_add_u32 v4, v5, 4, v4
    s_mov_b32 s54, 2
    s_mov_b32 s55, 0
.p2align 6
parallel_sum__mha_block__swiglu_ffn__prompt_kernel_unit:
    s_cmp_eq_u32 s29, 1
    s_cbranch_scc1 parallel_sum__mha_block__swiglu_ffn__prompt_kernel_bodyV
    s_cmp_eq_u32 s29, 2
    s_cbranch_scc1 parallel_sum__mha_block__swiglu_ffn__prompt_kernel_bodyG0
    s_cmp_eq_u32 s29, 3
    s_cbranch_scc1 parallel_sum__mha_block__swiglu_ffn__prompt_kernel_bodyG1
    s_add_u32 m0, s33, 0
    ds_read_b64_tr_b16 v[20:21], v3 offset:38912
    ds_read_b64_tr_b16 v[22:23], v3 offset:39424
    buffer_load_dwordx4 v2, s[16:19], s32 offen lds
    s_waitcnt lgkmcnt(6)
    v_mfma_f32_32x32x16_bf16 v[32:47], v[8:11], v[192:195], 0
    ds_read_b64_tr_b16 v[8:9], v3 offset:40960
    ds_read_b64_tr_b16 v[10:11], v3 offset:41472
    s_waitcnt lgkmcnt(6)
    v_mfma_f32_32x32x16_bf16 v[32:47], v[12:15], v[196:199], v[32:47]
    s_add_u32 m0, s33, 1024
    s_add_u32 s46, s32, s44
    ds_read_b64_tr_b16 v[12:13], v3 offset:43008
    ds_read_b64_tr_b16 v[14:15], v3 offset:43520
    buffer_load_dwordx4 v2, s[16:19], s46 offen lds
    s_add_u32 s32, s32, s45
    s_waitcnt lgkmcnt(6)
    v_mfma_f32_32x32x16_bf16 v[32:47], v[16:19], v[200:203], v[32:47]
    ds_read_b64_tr_b16 v[16:17], v3 offset:45056
    ds_read_b64_tr_b16 v[18:19], v3 offset:45568
    s_waitcnt lgkmcnt(6)
    v_mfma_f32_32x32x16_bf16 v[32:47], v[20:23], v[204:207], v[32:47]
    s_add_u32 m0, s33, 16384
    ds_read_b64_tr_b16 v[20:21], v3 offset:47104
    ds_read_b64_tr_b16 v[22:23], v3 offset:47616
    buffer_load_dwordx4 v2, s[16:19], s32 offen lds
    s_waitcnt lgkmcnt(6)
    v_mfma_f32_32x32x16_bf16 v[32:47], v[8:11], v[208:211], v[32:47]
    ds_read_b64_tr_b16 v[8:9], v3 offset:49152
    ds_read_b64_tr_b16 v[10:11], v3 offset:49664
    s_waitcnt lgkmcnt(6)
    v_mfma_f32_32x32x16_bf16 v[32:47], v[12:15], v[212:215], v[32:47]
    s_add_u32 m0, s33, 17408
    s_add_u32 s46, s32, s44
    ds_read_b64_tr_b16 v[12:13], v3 offset:51200
    ds_read_b64_tr_b16 v[14:15], v3 offset:51712
    buffer_load_dwordx4 v2, s[16:19], s46 offen lds
    s_add_u32 s32, s32, s45
    s_waitcnt lgkmcnt(6)
    v_mfma_f32_32x32x16_bf16 v[32:47], v[16:19], v[216:219], v[32:47]
    ds_read_b64_tr_b16 v[16:17], v3 offset:53248
    ds_read_b64_tr_b16 v[18:19], v3 offset:53760
    s_waitcnt lgkmcnt(6)
    v_mfma_f32_32x32x16_bf16 v[32:47], v[20:23], v[220:223], v[32:47]
    s_add_u32 m0, s33, 32768
    ds_read_b64_tr_b16 v[20:21], v3 offset:55296
    ds_read_b64_tr_b16 v[22:23], v3 offset:55808
    buffer_load_dwordx4 v2, s[16:19], s32 offen lds
    s_waitcnt lgkmcnt(6)
    v_mfma_f32_32x32x16_bf16 v[32:47], v[8:11], v[224:227], v[32:47]
    ds_read_b64_tr_b16 v[8:9], v3 offset:57344
    ds_read_b64_tr_b16 v[10:11], v3 offset:57856
    s_waitcnt lgkmcnt(6)
    v_mfma_f32_32x32x16_bf16 v[32:47], v[12:15], v[228:231], v[32:47]
    s_add_u32 m0, s33, 33792
    s_add_u32 s46, s32, s44
    ds_read_b64_tr_b16 v[12:13], v3 offset:59392
    ds_read_b64_tr_b16 v[14:15], v3 offset:59904
    buffer_load_dwordx4 v2, s[16:19], s46 offen lds
    s_add_u32 s32, s32, s45
    s_waitcnt lgkmcnt(6)
    v_mfma_f32_32x32x16_bf16 v[32:47], v[16:19], v[232:235], v[32:47]
    ds_read_b64_tr_b16 v[16:17], v3 offset:61440
    ds_read_b64_tr_b16 v[18:19], v3 offset:61952
    s_waitcnt lgkmcnt(6)
    v_mfma_f32_32x32x16_bf16 v[32:47], v[20:23], v[236:239], v[32:47]
    s_add_u32 m0, s33, 49152
    ds_read_b64_tr_b16 v[20:21], v3 offset:63488
    ds_read_b64_tr_b16 v[22:23], v3 offset:64000
    buffer_load_dwordx4 v2, s[16:19], s32 offen lds
    s_waitcnt lgkmcnt(6)
    v_mfma_f32_32x32x16_bf16 v[32:47], v[8:11], v[240:243], v[32:47]
    s_cmp_lg_u32 s28, 0
    s_cbranch_scc1 parallel_sum__mha_block__swiglu_ffn__prompt_kernel_mid0
    s_waitcnt vmcnt(7)
    s_barrier
parallel_sum__mha_block__swiglu_ffn__prompt_kernel_mid0:
    ds_read_b64_tr_b16 v[8:9], v3 offset:0
    ds_read_b64_tr_b16 v[10:11], v3 offset:512
    s_waitcnt lgkmcnt(6)
    v_mfma_f32_32x32x16_bf16 v[32:47], v[12:15], v[244:247], v[32:47]
    s_add_u32 m0, s33, 50176
    s_add_u32 s46, s32, s44
    ds_read_b64_tr_b16 v[12:13], v3 offset:2048
    ds_read_b64_tr_b16 v[14:15], v3 offset:2560
    buffer_load_dwordx4 v2, s[16:19], s46 offen lds
    s_add_u32 s32, s32, s45
    s_waitcnt lgkmcnt(6)
    v_mfma_f32_32x32x16_bf16 v[32:47], v[16:19], v[248:251], v[32:47]
    ds_read_b64_tr_b16 v[16:17], v3 offset:4096
    ds_read_b64_tr_b16 v[18:19], v3 offset:4608
    s_waitcnt lgkmcnt(6)
    v_mfma_f32_32x32x16_bf16 v[32:47], v[20:23], v[252:255], v[32:47]
    s_mov_b32 s56, s54
    s_mov_b32 s57, s55
    s_mov_b32 s54, s29
    ds_read_b64_tr_b16 v[20:21], v3 offset:6144
    ds_read_b64_tr_b16 v[22:23], v3 offset:6656
    s_waitcnt lgkmcnt(6)
    v_mfma_f32_32x32x16_bf16 v[32:47], v[8:11], v[128:131], v[32:47]
    s_mov_b32 s55, s30
    s_mov_b32 s29, s52
    s_mov_b32 s30, s53
    ds_read_b64_tr_b16 v[8:9], v3 offset:8192
    ds_read_b64_tr_b16 v[10:11], v3 offset:8704
    s_waitcnt lgkmcnt(6)
    v_mfma_f32_32x32x16_bf16 v[32:47], v[12:15], v[132:135], v[32:47]
    s_add_u32 s28, s28, 1
    s_add_u32 s47, s28, 1
    s_lshl_b32 s33, s24, 11
    ds_read_b64_tr_b16 v[12:13], v3 offset:10240
    ds_read_b64_tr_b16 v[14:15], v3 offset:10752
    s_waitcnt lgkmcnt(6)
    v_mfma_f32_32x32x16_bf16 v[32:47], v[16:19], v[136:139], v[32:47]
    s_bitcmp0_b32 s47, 0
    s_cselect_b32 s40, 98304, 0
    s_add_u32 s33, s33, s40
    ds_read_b64_tr_b16 v[16:17], v3 offset:12288
    ds_read_b64_tr_b16 v[18:19], v3 offset:12800
    s_waitcnt lgkmcnt(6)
    v_mfma_f32_32x32x16_bf16 v[32:47], v[20:23], v[140:143], v[32:47]
    s_lshl_b32 s40, s47, 1
    s_mul_i32 s41, s47, 6
    s_lshr_b32 s52, s62, s40
    ds_read_b64_tr_b16 v[20:21], v3 offset:14336
    ds_read_b64_tr_b16 v[22:23], v3 offset:14848
    s_waitcnt lgkmcnt(6)
    v_mfma_f32_32x32x16_bf16 v[32:47], v[8:11], v[144:147], v[32:47]
    s_lshr_b32 s53, s63, s41
    s_and_b32 s52, s52, 3
    s_and_b32 s53, s53, 63
    ds_read_b64_tr_b16 v[8:9], v3 offset:16384
    ds_read_b64_tr_b16 v[10:11], v3 offset:16896
    s_waitcnt lgkmcnt(6)
    v_mfma_f32_32x32x16_bf16 v[32:47], v[12:15], v[148:151], v[32:47]
    s_lshl_b32 s42, s53, 7
    s_and_b32 s40, s52, 1
    s_lshl_b32 s40, s40, 8
    ds_read_b64_tr_b16 v[12:13], v3 offset:18432
    ds_read_b64_tr_b16 v[14:15], v3 offset:18944
    s_waitcnt lgkmcnt(6)
    v_mfma_f32_32x32x16_bf16 v[32:47], v[16:19], v[152:155], v[32:47]
    s_lshr_b32 s41, s24, 1
    s_lshl_b32 s41, s41, 4
    s_add_u32 s40, s40, s41
    ds_read_b64_tr_b16 v[16:17], v3 offset:20480
    ds_read_b64_tr_b16 v[18:19], v3 offset:20992
    s_waitcnt lgkmcnt(6)
    v_mfma_f32_32x32x16_bf16 v[32:47], v[20:23], v[156:159], v[32:47]
    s_lshl_b32 s41, s24, 4
    s_cmp_lt_u32 s52, 2
    s_cselect_b32 s16, s66, s8
    ds_read_b64_tr_b16 v[20:21], v3 offset:22528
    ds_read_b64_tr_b16 v[22:23], v3 offset:23040
    s_waitcnt lgkmcnt(6)
    v_mfma_f32_32x32x16_bf16 v[32:47], v[8:11], v[160:163], v[32:47]
    s_cselect_b32 s17, s67, s9
    s_cselect_b32 s31, 6, 7
    s_cselect_b32 s32, s41, s40
    ds_read_b64_tr_b16 v[8:9], v3 offset:24576
    ds_read_b64_tr_b16 v[10:11], v3 offset:25088
    s_waitcnt lgkmcnt(6)
    v_mfma_f32_32x32x16_bf16 v[32:47], v[12:15], v[164:167], v[32:47]
    s_cselect_b32 s45, 128, 64
    s_lshl_b32 s31, s31, 9
    s_add_u32 s16, s16, s42
    ds_read_b64_tr_b16 v[12:13], v3 offset:26624
    ds_read_b64_tr_b16 v[14:15], v3 offset:27136
    s_waitcnt lgkmcnt(6)
    v_mfma_f32_32x32x16_bf16 v[32:47], v[16:19], v[168:171], v[32:47]
    s_addc_u32 s17, s17, 0
    s_lshl_b32 s18, s31, 9
    s_sub_u32 s18, s18, s42
    ds_read_b64_tr_b16 v[16:17], v3 offset:28672
    ds_read_b64_tr_b16 v[18:19], v3 offset:29184
    s_waitcnt lgkmcnt(6)
    v_mfma_f32_32x32x16_bf16 v[32:47], v[20:23], v[172:175], v[32:47]
    s_mul_i32 s32, s32, s31
    s_mul_i32 s45, s45, s31
    s_lshl_b32 s44, s31, 3
    ds_read_b64_tr_b16 v[20:21], v3 offset:30720
    ds_read_b64_tr_b16 v[22:23], v3 offset:31232
    s_waitcnt lgkmcnt(6)
    v_mfma_f32_32x32x16_bf16 v[32:47], v[8:11], v[176:179], v[32:47]
    v_mad_u32_u24 v2, v6, s31, v7
    s_cmp_lt_u32 s47, 5
    s_cselect_b32 s18, s18, 0
    s_waitcnt lgkmcnt(4)
    v_mfma_f32_32x32x16_bf16 v[32:47], v[12:15], v[180:183], v[32:47]
    s_cmp_lt_u32 s28, 5
    s_cselect_b32 s39, s39, 0
    s_waitcnt lgkmcnt(2)
    v_mfma_f32_32x32x16_bf16 v[32:47], v[16:19], v[184:187], v[32:47]
    s_waitcnt lgkmcnt(0)
    v_mfma_f32_32x32x16_bf16 v[32:47], v[20:23], v[188:191], v[32:47]
    s_branch parallel_sum__mha_block__swiglu_ffn__prompt_kernel_post
.p2align 6
parallel_sum__mha_block__swiglu_ffn__prompt_kernel_bodyV:
    s_add_u32 m0, s33, 0
    ds_read_b64_tr_b16 v[20:21], v3 offset:38912
    ds_read_b64_tr_b16 v[22:23], v3 offset:39424
    buffer_load_dwordx4 v2, s[16:19], s32 offen lds
    s_waitcnt lgkmcnt(6)
    s_nop 3
    v_mfma_f32_32x32x16_bf16 v[32:47], v[192:195], v[8:11], 0
    ds_read_b64_tr_b16 v[8:9], v3 offset:40960
    ds_read_b64_tr_b16 v[10:11], v3 offset:41472
    s_waitcnt lgkmcnt(6)
    v_mfma_f32_32x32x16_bf16 v[32:47], v[196:199], v[12:15], v[32:47]
    s_add_u32 m0, s33, 1024
    s_add_u32 s46, s32, s44
    ds_read_b64_tr_b16 v[12:13], v3 offset:43008
    ds_read_b64_tr_b16 v[14:15], v3 offset:43520
    buffer_load_dwordx4 v2, s[16:19], s46 offen lds
    s_add_u32 s32, s32, s45
    s_waitcnt lgkmcnt(6)
    v_mfma_f32_32x32x16_bf16 v[32:47], v[200:203], v[16:19], v[32:47]
    ds_read_b64_tr_b16 v[16:17], v3 offset:45056
    ds_read_b64_tr_b16 v[18:19], v3 offset:45568
    s_waitcnt lgkmcnt(6)
    v_mfma_f32_32x32x16_bf16 v[32:47], v[204:207], v[20:23], v[32:47]
    s_add_u32 m0, s33, 16384
    ds_read_b64_tr_b16 v[20:21], v3 offset:47104
    ds_read_b64_tr_b16 v[22:23], v3 offset:47616
    buffer_load_dwordx4 v2, s[16:19], s32 offen lds
    s_waitcnt lgkmcnt(6)
    v_mfma_f32_32x32x16_bf16 v[32:47], v[208:211], v[8:11], v[32:47]
    ds_read_b64_tr_b16 v[8:9], v3 offset:49152
    ds_read_b64_tr_b16 v[10:11], v3 offset:49664
    s_waitcnt lgkmcnt(6)
    v_mfma_f32_32x32x16_bf16 v[32:47], v[212:215], v[12:15], v[32:47]
    s_add_u32 m0, s33, 17408
    s_add_u32 s46, s32, s44
    ds_read_b64_tr_b16 v[12:13], v3 offset:51200
    ds_read_b64_tr_b16 v[14:15], v3 offset:51712
    buffer_load_dwordx4 v2, s[16:19], s46 offen lds
    s_add_u32 s32, s32, s45
    s_waitcnt lgkmcnt(6)
    v_mfma_f32_32x32x16_bf16 v[32:47], v[216:219], v[16:19], v[32:47]
    ds_read_b64_tr_b16 v[16:17], v3 offset:53248
    ds_read_b64_tr_b16 v[18:19], v3 offset:53760
    s_waitcnt lgkmcnt(6)
    v_mfma_f32_32x32x16_bf16 v[32:47], v[220:223], v[20:23], v[32:47]
    s_add_u32 m0, s33, 32768
    ds_read_b64_tr_b16 v[20:21], v3 offset:55296
    ds_read_b64_tr_b16 v[22:23], v3 offset:55808
    buffer_load_dwordx4 v2, s[16:19], s32 offen lds
    s_waitcnt lgkmcnt(6)
    v_mfma_f32_32x32x16_bf16 v[32:47], v[224:227], v[8:11], v[32:47]
    ds_read_b64_tr_b16 v[8:9], v3 offset:57344
    ds_read_b64_tr_b16 v[10:11], v3 offset:57856
    s_waitcnt lgkmcnt(6)
    v_mfma_f32_32x32x16_bf16 v[32:47], v[228:231], v[12:15], v[32:47]
    s_add_u32 m0, s33, 33792
    s_add_u32 s46, s32, s44
    ds_read_b64_tr_b16 v[12:13], v3 offset:59392
    ds_read_b64_tr_b16 v[14:15], v3 offset:59904
    buffer_load_dwordx4 v2, s[16:19], s46 offen lds
    s_add_u32 s32, s32, s45
    s_waitcnt lgkmcnt(6)
    v_mfma_f32_32x32x16_bf16 v[32:47], v[232:235], v[16:19], v[32:47]
    ds_read_b64_tr_b16 v[16:17], v3 offset:61440
    ds_read_b64_tr_b16 v[18:19], v3 offset:61952
    s_waitcnt lgkmcnt(6)
    v_mfma_f32_32x32x16_bf16 v[32:47], v[236:239], v[20:23], v[32:47]
    s_add_u32 m0, s33, 49152
    ds_read_b64_tr_b16 v[20:21], v3 offset:63488
    ds_read_b64_tr_b16 v[22:23], v3 offset:64000
    buffer_load_dwordx4 v2, s[16:19], s32 offen lds
    s_waitcnt lgkmcnt(6)
    v_mfma_f32_32x32x16_bf16 v[32:47], v[240:243], v[8:11], v[32:47]
    ds_read_b64_tr_b16 v[8:9], v3 offset:0
    ds_read_b64_tr_b16 v[10:11], v3 offset:512
    s_waitcnt lgkmcnt(6)
    v_mfma_f32_32x32x16_bf16 v[32:47], v[244:247], v[12:15], v[32:47]
    s_add_u32 m0, s33, 50176
    s_add_u32 s46, s32, s44
    ds_read_b64_tr_b16 v[12:13], v3 offset:2048
    ds_read_b64_tr_b16 v[14:15], v3 offset:2560
    buffer_load_dwordx4 v2, s[16:19], s46 offen lds
    s_add_u32 s32, s32, s45
    s_waitcnt lgkmcnt(6)
    v_mfma_f32_32x32x16_bf16 v[32:47], v[248:251], v[16:19], v[32:47]
    ds_read_b64_tr_b16 v[16:17], v3 offset:4096
    ds_read_b64_tr_b16 v[18:19], v3 offset:4608
    s_waitcnt lgkmcnt(6)
    v_mfma_f32_32x32x16_bf16 v[32:47], v[252:255], v[20:23], v[32:47]
    s_mov_b32 s56, s54
    s_mov_b32 s57, s55
    s_mov_b32 s54, s29
    ds_read_b64_tr_b16 v[20:21], v3 offset:6144
    ds_read_b64_tr_b16 v[22:23], v3 offset:6656
    s_waitcnt lgkmcnt(6)
    v_mfma_f32_32x32x16_bf16 v[32:47], v[128:131], v[8:11], v[32:47]
    s_mov_b32 s55, s30
    s_mov_b32 s29, s52
    s_mov_b32 s30, s53
    ds_read_b64_tr_b16 v[8:9], v3 offset:8192
    ds_read_b64_tr_b16 v[10:11], v3 offset:8704
    s_waitcnt lgkmcnt(6)
    v_mfma_f32_32x32x16_bf16 v[32:47], v[132:135], v[12:15], v[32:47]
    s_add_u32 s28, s28, 1
    s_add_u32 s47, s28, 1
    s_lshl_b32 s33, s24, 11
    ds_read_b64_tr_b16 v[12:13], v3 offset:10240
    ds_read_b64_tr_b16 v[14:15], v3 offset:10752
    s_waitcnt lgkmcnt(6)
    v_mfma_f32_32x32x16_bf16 v[32:47], v[136:139], v[16:19], v[32:47]
    s_bitcmp0_b32 s47, 0
    s_cselect_b32 s40, 98304, 0
    s_add_u32 s33, s33, s40
    ds_read_b64_tr_b16 v[16:17], v3 offset:12288
    ds_read_b64_tr_b16 v[18:19], v3 offset:12800
    s_waitcnt lgkmcnt(6)
    v_mfma_f32_32x32x16_bf16 v[32:47], v[140:143], v[20:23], v[32:47]
    s_lshl_b32 s40, s47, 1
    s_mul_i32 s41, s47, 6
    s_lshr_b32 s52, s62, s40
    ds_read_b64_tr_b16 v[20:21], v3 offset:14336
    ds_read_b64_tr_b16 v[22:23], v3 offset:14848
    s_waitcnt lgkmcnt(6)
    v_mfma_f32_32x32x16_bf16 v[32:47], v[144:147], v[8:11], v[32:47]
    s_lshr_b32 s53, s63, s41
    s_and_b32 s52, s52, 3
    s_and_b32 s53, s53, 63
    ds_read_b64_tr_b16 v[8:9], v3 offset:16384
    ds_read_b64_tr_b16 v[10:11], v3 offset:16896
    s_waitcnt lgkmcnt(6)
    v_mfma_f32_32x32x16_bf16 v[32:47], v[148:151], v[12:15], v[32:47]
    s_lshl_b32 s42, s53, 7
    s_and_b32 s40, s52, 1
    s_lshl_b32 s40, s40, 8
    ds_read_b64_tr_b16 v[12:13], v3 offset:18432
    ds_read_b64_tr_b16 v[14:15], v3 offset:18944
    s_waitcnt lgkmcnt(6)
    v_mfma_f32_32x32x16_bf16 v[32:47], v[152:155], v[16:19], v[32:47]
    s_lshr_b32 s41, s24, 1
    s_lshl_b32 s41, s41, 4
    s_add_u32 s40, s40, s41
    ds_read_b64_tr_b16 v[16:17], v3 offset:20480
    ds_read_b64_tr_b16 v[18:19], v3 offset:20992
    s_waitcnt lgkmcnt(6)
    v_mfma_f32_32x32x16_bf16 v[32:47], v[156:159], v[20:23], v[32:47]
    s_lshl_b32 s41, s24, 4
    s_cmp_lt_u32 s52, 2
    s_cselect_b32 s16, s66, s8
    ds_read_b64_tr_b16 v[20:21], v3 offset:22528
    ds_read_b64_tr_b16 v[22:23], v3 offset:23040
    s_waitcnt lgkmcnt(6)
    v_mfma_f32_32x32x16_bf16 v[32:47], v[160:163], v[8:11], v[32:47]
    s_cselect_b32 s17, s67, s9
    s_cselect_b32 s31, 6, 7
    s_cselect_b32 s32, s41, s40
    ds_read_b64_tr_b16 v[8:9], v3 offset:24576
    ds_read_b64_tr_b16 v[10:11], v3 offset:25088
    s_waitcnt lgkmcnt(6)
    v_mfma_f32_32x32x16_bf16 v[32:47], v[164:167], v[12:15], v[32:47]
    s_cselect_b32 s45, 128, 64
    s_lshl_b32 s31, s31, 9
    s_add_u32 s16, s16, s42
    ds_read_b64_tr_b16 v[12:13], v3 offset:26624
    ds_read_b64_tr_b16 v[14:15], v3 offset:27136
    s_waitcnt lgkmcnt(6)
    v_mfma_f32_32x32x16_bf16 v[32:47], v[168:171], v[16:19], v[32:47]
    s_addc_u32 s17, s17, 0
    s_lshl_b32 s18, s31, 9
    s_sub_u32 s18, s18, s42
    ds_read_b64_tr_b16 v[16:17], v3 offset:28672
    ds_read_b64_tr_b16 v[18:19], v3 offset:29184
    s_waitcnt lgkmcnt(6)
    v_mfma_f32_32x32x16_bf16 v[32:47], v[172:175], v[20:23], v[32:47]
    s_mul_i32 s32, s32, s31
    s_mul_i32 s45, s45, s31
    s_lshl_b32 s44, s31, 3
    ds_read_b64_tr_b16 v[20:21], v3 offset:30720
    ds_read_b64_tr_b16 v[22:23], v3 offset:31232
    s_waitcnt lgkmcnt(6)
    v_mfma_f32_32x32x16_bf16 v[32:47], v[176:179], v[8:11], v[32:47]
    v_mad_u32_u24 v2, v6, s31, v7
    s_cmp_lt_u32 s47, 5
    s_cselect_b32 s18, s18, 0
    s_waitcnt lgkmcnt(4)
    v_mfma_f32_32x32x16_bf16 v[32:47], v[180:183], v[12:15], v[32:47]
    s_cmp_lt_u32 s28, 5
    s_cselect_b32 s39, s39, 0
    s_waitcnt lgkmcnt(2)
    v_mfma_f32_32x32x16_bf16 v[32:47], v[184:187], v[16:19], v[32:47]
    s_waitcnt lgkmcnt(0)
    v_mfma_f32_32x32x16_bf16 v[32:47], v[188:191], v[20:23], v[32:47]
    s_branch parallel_sum__mha_block__swiglu_ffn__prompt_kernel_post
.p2align 6
parallel_sum__mha_block__swiglu_ffn__prompt_kernel_bodyG0:
    s_add_u32 m0, s33, 0
    ds_read_b64_tr_b16 v[20:21], v3 offset:38912
    ds_read_b64_tr_b16 v[22:23], v3 offset:39424
    buffer_load_dwordx4 v2, s[16:19], s32 offen lds
    s_waitcnt lgkmcnt(6)
    s_nop 3
    v_mfma_f32_32x32x16_bf16 v[32:47], v[8:11], v[160:163], 0
    ds_read_b64_tr_b16 v[8:9], v3 offset:40960
    ds_read_b64_tr_b16 v[10:11], v3 offset:41472
    s_waitcnt lgkmcnt(6)
    v_mfma_f32_32x32x16_bf16 v[48:63], v[12:15], v[160:163], 0
    s_add_u32 m0, s33, 1024
    s_add_u32 s46, s32, s44
    ds_read_b64_tr_b16 v[12:13], v3 offset:43008
    ds_read_b64_tr_b16 v[14:15], v3 offset:43520
    buffer_load_dwordx4 v2, s[16:19], s46 offen lds
    s_add_u32 s32, s32, s45
    s_waitcnt lgkmcnt(6)
    v_mfma_f32_32x32x16_bf16 v[32:47], v[16:19], v[164:167], v[32:47]
    ds_read_b64_tr_b16 v[16:17], v3 offset:45056
    ds_read_b64_tr_b16 v[18:19], v3 offset:45568
    s_waitcnt lgkmcnt(6)
    v_mfma_f32_32x32x16_bf16 v[48:63], v[20:23], v[164:167], v[48:63]
    s_add_u32 m0, s33, 16384
    ds_read_b64_tr_b16 v[20:21], v3 offset:47104
    ds_read_b64_tr_b16 v[22:23], v3 offset:47616
    buffer_load_dwordx4 v2, s[16:19], s32 offen lds
    s_waitcnt lgkmcnt(6)
    v_mfma_f32_32x32x16_bf16 v[32:47], v[8:11], v[168:171], v[32:47]
    ds_read_b64_tr_b16 v[8:9], v3 offset:49152
    ds_read_b64_tr_b16 v[10:11], v3 offset:49664
    s_waitcnt lgkmcnt(6)
    v_mfma_f32_32x32x16_bf16 v[48:63], v[12:15], v[168:171], v[48:63]
    s_add_u32 m0, s33, 17408
    s_add_u32 s46, s32, s44
    ds_read_b64_tr_b16 v[12:13], v3 offset:51200
    ds_read_b64_tr_b16 v[14:15], v3 offset:51712
    buffer_load_dwordx4 v2, s[16:19], s46 offen lds
    s_add_u32 s32, s32, s45
    s_waitcnt lgkmcnt(6)
    v_mfma_f32_32x32x16_bf16 v[32:47], v[16:19], v[172:175], v[32:47]
    ds_read_b64_tr_b16 v[16:17], v3 offset:53248
    ds_read_b64_tr_b16 v[18:19], v3 offset:53760
    s_waitcnt lgkmcnt(6)
    v_mfma_f32_32x32x16_bf16 v[48:63], v[20:23], v[172:175], v[48:63]
    s_add_u32 m0, s33, 32768
    ds_read_b64_tr_b16 v[20:21], v3 offset:55296
    ds_read_b64_tr_b16 v[22:23], v3 offset:55808
    buffer_load_dwordx4 v2, s[16:19], s32 offen lds
    s_waitcnt lgkmcnt(6)
    v_mfma_f32_32x32x16_bf16 v[32:47], v[8:11], v[176:179], v[32:47]
    ds_read_b64_tr_b16 v[8:9], v3 offset:57344
    ds_read_b64_tr_b16 v[10:11], v3 offset:57856
    s_waitcnt lgkmcnt(6)
    v_mfma_f32_32x32x16_bf16 v[48:63], v[12:15], v[176:179], v[48:63]
    s_add_u32 m0, s33, 33792
    s_add_u32 s46, s32, s44
    ds_read_b64_tr_b16 v[12:13], v3 offset:59392
    ds_read_b64_tr_b16 v[14:15], v3 offset:59904
    buffer_load_dwordx4 v2, s[16:19], s46 offen lds
    s_add_u32 s32, s32, s45
    s_waitcnt lgkmcnt(6)
    v_mfma_f32_32x32x16_bf16 v[32:47], v[16:19], v[180:183], v[32:47]
    ds_read_b64_tr_b16 v[16:17], v3 offset:61440
    ds_read_b64_tr_b16 v[18:19], v3 offset:61952
    s_waitcnt lgkmcnt(6)
    v_mfma_f32_32x32x16_bf16 v[48:63], v[20:23], v[180:183], v[48:63]
    s_add_u32 m0, s33, 49152
    ds_read_b64_tr_b16 v[20:21], v3 offset:63488
    ds_read_b64_tr_b16 v[22:23], v3 offset:64000
    buffer_load_dwordx4 v2, s[16:19], s32 offen lds
    s_waitcnt lgkmcnt(6)
    v_mfma_f32_32x32x16_bf16 v[32:47], v[8:11], v[184:187], v[32:47]
    s_cmp_lg_u32 s28, 0
    s_cbranch_scc1 parallel_sum__mha_block__swiglu_ffn__prompt_kernel_mid2
    s_waitcnt vmcnt(7)
    s_barrier
parallel_sum__mha_block__swiglu_ffn__prompt_kernel_mid2:
    ds_read_b64_tr_b16 v[8:9], v3 offset:0
    ds_read_b64_tr_b16 v[10:11], v3 offset:512
    s_waitcnt lgkmcnt(6)
    v_mfma_f32_32x32x16_bf16 v[48:63], v[12:15], v[184:187], v[48:63]
    s_add_u32 m0, s33, 50176
    s_add_u32 s46, s32, s44
    ds_read_b64_tr_b16 v[12:13], v3 offset:2048
    ds_read_b64_tr_b16 v[14:15], v3 offset:2560
    buffer_load_dwordx4 v2, s[16:19], s46 offen lds
    s_add_u32 s32, s32, s45
    s_waitcnt lgkmcnt(6)
    v_mfma_f32_32x32x16_bf16 v[32:47], v[16:19], v[188:191], v[32:47]
    ds_read_b64_tr_b16 v[16:17], v3 offset:4096
    ds_read_b64_tr_b16 v[18:19], v3 offset:4608
    s_waitcnt lgkmcnt(6)
    v_mfma_f32_32x32x16_bf16 v[48:63], v[20:23], v[188:191], v[48:63]
    s_mov_b32 s56, s54
    s_mov_b32 s57, s55
    s_mov_b32 s54, s29
    s_mov_b32 s55, s30
    s_mov_b32 s29, s52
    ds_read_b64_tr_b16 v[20:21], v3 offset:6144
    ds_read_b64_tr_b16 v[22:23], v3 offset:6656
    s_waitcnt lgkmcnt(6)
    v_mfma_f32_32x32x16_bf16 v[32:47], v[8:11], v[128:131], v[32:47]
    s_mov_b32 s30, s53
    s_add_u32 s28, s28, 1
    s_add_u32 s47, s28, 1
    s_lshl_b32 s33, s24, 11
    s_bitcmp0_b32 s47, 0
    ds_read_b64_tr_b16 v[8:9], v3 offset:8192
    ds_read_b64_tr_b16 v[10:11], v3 offset:8704
    s_waitcnt lgkmcnt(6)
    v_mfma_f32_32x32x16_bf16 v[48:63], v[12:15], v[128:131], v[48:63]
    s_cselect_b32 s40, 98304, 0
    s_add_u32 s33, s33, s40
    s_lshl_b32 s40, s47, 1
    s_mul_i32 s41, s47, 6
    s_lshr_b32 s52, s62, s40
    ds_read_b64_tr_b16 v[12:13], v3 offset:10240
    ds_read_b64_tr_b16 v[14:15], v3 offset:10752
    s_waitcnt lgkmcnt(6)
    v_mfma_f32_32x32x16_bf16 v[32:47], v[16:19], v[132:135], v[32:47]
    s_lshr_b32 s53, s63, s41
    s_and_b32 s52, s52, 3
    s_and_b32 s53, s53, 63
    s_lshl_b32 s42, s53, 7
    s_and_b32 s40, s52, 1
    ds_read_b64_tr_b16 v[16:17], v3 offset:12288
    ds_read_b64_tr_b16 v[18:19], v3 offset:12800
    s_waitcnt lgkmcnt(6)
    v_mfma_f32_32x32x16_bf16 v[48:63], v[20:23], v[132:135], v[48:63]
    s_lshl_b32 s40, s40, 8
    s_lshr_b32 s41, s24, 1
    s_lshl_b32 s41, s41, 4
    s_add_u32 s40, s40, s41
    s_lshl_b32 s41, s24, 4
    ds_read_b64_tr_b16 v[20:21], v3 offset:14336
    ds_read_b64_tr_b16 v[22:23], v3 offset:14848
    s_waitcnt lgkmcnt(6)
    v_mfma_f32_32x32x16_bf16 v[32:47], v[8:11], v[136:139], v[32:47]
    s_cmp_lt_u32 s52, 2
    s_cselect_b32 s16, s66, s8
    s_cselect_b32 s17, s67, s9
    s_cselect_b32 s31, 6, 7
    s_cselect_b32 s32, s41, s40
    ds_read_b64_tr_b16 v[8:9], v3 offset:16384
    ds_read_b64_tr_b16 v[10:11], v3 offset:16896
    s_waitcnt lgkmcnt(6)
    v_mfma_f32_32x32x16_bf16 v[48:63], v[12:15], v[136:139], v[48:63]
    s_cselect_b32 s45, 128, 64
    s_lshl_b32 s31, s31, 9
    s_add_u32 s16, s16, s42
    s_addc_u32 s17, s17, 0
    s_lshl_b32 s18, s31, 9
    ds_read_b64_tr_b16 v[12:13], v3 offset:18432
    ds_read_b64_tr_b16 v[14:15], v3 offset:18944
    s_waitcnt lgkmcnt(6)
    v_mfma_f32_32x32x16_bf16 v[32:47], v[16:19], v[140:143], v[32:47]
    s_sub_u32 s18, s18, s42
    s_mul_i32 s32, s32, s31
    s_mul_i32 s45, s45, s31
    s_lshl_b32 s44, s31, 3
    v_mad_u32_u24 v2, v6, s31, v7
    ds_read_b64_tr_b16 v[16:17], v3 offset:20480
    ds_read_b64_tr_b16 v[18:19], v3 offset:20992
    s_waitcnt lgkmcnt(6)
    v_mfma_f32_32x32x16_bf16 v[48:63], v[20:23], v[140:143], v[48:63]
    s_cmp_lt_u32 s47, 5
    s_cselect_b32 s18, s18, 0
    s_cmp_lt_u32 s28, 5
    s_cselect_b32 s39, s39, 0
    s_lshr_b32 s48, s2, 3
    ds_read_b64_tr_b16 v[20:21], v3 offset:22528
    ds_read_b64_tr_b16 v[22:23], v3 offset:23040
    s_waitcnt lgkmcnt(6)
    v_mfma_f32_32x32x16_bf16 v[32:47], v[8:11], v[144:147], v[32:47]
    s_lshl_b32 s48, s48, 3
    s_add_u32 s48, s48, s24
    s_and_b32 s50, s2, 1
    s_lshl_b32 s50, s50, 9
    v_lshrrev_b32 v106, 5, v0
    ds_read_b64_tr_b16 v[8:9], v3 offset:24576
    ds_read_b64_tr_b16 v[10:11], v3 offset:25088
    s_waitcnt lgkmcnt(6)
    v_mfma_f32_32x32x16_bf16 v[48:63], v[12:15], v[144:147], v[48:63]
    v_lshlrev_b32 v106, 10, v106
    v_and_b32 v107, 31, v0
    v_lshl_add_u32 v106, v107, 4, v106
    s_mul_i32 s51, s48, 7168
    s_add_u32 s51, s51, s50
    ds_read_b64_tr_b16 v[12:13], v3 offset:26624
    ds_read_b64_tr_b16 v[14:15], v3 offset:27136
    s_waitcnt lgkmcnt(6)
    v_mfma_f32_32x32x16_bf16 v[32:47], v[16:19], v[148:151], v[32:47]
    s_mov_b32 s20, s76
    s_mov_b32 s21, s77
    s_mov_b32 s22, 1835008
    s_mov_b32 s23, 0x00020000
    s_cmp_eq_u32 s28, 4
    ds_read_b64_tr_b16 v[16:17], v3 offset:28672
    ds_read_b64_tr_b16 v[18:19], v3 offset:29184
    s_waitcnt lgkmcnt(6)
    v_mfma_f32_32x32x16_bf16 v[48:63], v[20:23], v[148:151], v[48:63]
    s_cselect_b32 s22, s22, 0
    buffer_load_dwordx4 v[96:99], v106, s[20:23], s51 offen offset:0
    buffer_load_dwordx4 v[96:99], v106, s[20:23], s51 offen offset:2048
    s_add_u32 s51, s51, 4096
    buffer_load_dwordx4 v[96:99], v106, s[20:23], s51 offen offset:0
    ds_read_b64_tr_b16 v[20:21], v3 offset:30720
    ds_read_b64_tr_b16 v[22:23], v3 offset:31232
    s_waitcnt lgkmcnt(6)
    v_mfma_f32_32x32x16_bf16 v[32:47], v[8:11], v[152:155], v[32:47]
    buffer_load_dwordx4 v[96:99], v106, s[20:23], s51 offen offset:2048
    s_lshl_b32 s51, s48, 11
    s_add_u32 s51, s51, s50
    s_mov_b32 s20, s68
    s_mov_b32 s21, s69
    s_waitcnt lgkmcnt(4)
    v_mfma_f32_32x32x16_bf16 v[48:63], v[12:15], v[152:155], v[48:63]
    s_mov_b32 s22, 524288
    s_mov_b32 s23, 0x00020000
    s_cmp_eq_u32 s28, 4
    s_cselect_b32 s22, s22, 0
    buffer_load_dwordx4 v[96:99], v106, s[20:23], s51 offen
    s_waitcnt lgkmcnt(2)
    v_mfma_f32_32x32x16_bf16 v[32:47], v[16:19], v[156:159], v[32:47]
    s_waitcnt lgkmcnt(0)
    v_mfma_f32_32x32x16_bf16 v[48:63], v[20:23], v[156:159], v[48:63]
    s_branch parallel_sum__mha_block__swiglu_ffn__prompt_kernel_post
.p2align 6
parallel_sum__mha_block__swiglu_ffn__prompt_kernel_bodyG1:
    s_add_u32 m0, s33, 0
    ds_read_b64_tr_b16 v[20:21], v3 offset:38912
    ds_read_b64_tr_b16 v[22:23], v3 offset:39424
    buffer_load_dwordx4 v2, s[16:19], s32 offen lds
    s_waitcnt lgkmcnt(6)
    v_mfma_f32_32x32x16_bf16 v[32:47], v[8:11], v[224:227], v[32:47]
    ds_read_b64_tr_b16 v[8:9], v3 offset:40960
    ds_read_b64_tr_b16 v[10:11], v3 offset:41472
    s_waitcnt lgkmcnt(6)
    v_mfma_f32_32x32x16_bf16 v[48:63], v[12:15], v[224:227], v[48:63]
    s_add_u32 m0, s33, 1024
    s_add_u32 s46, s32, s44
    ds_read_b64_tr_b16 v[12:13], v3 offset:43008
    ds_read_b64_tr_b16 v[14:15], v3 offset:43520
    buffer_load_dwordx4 v2, s[16:19], s46 offen lds
    s_add_u32 s32, s32, s45
    s_waitcnt lgkmcnt(6)
    v_mfma_f32_32x32x16_bf16 v[32:47], v[16:19], v[228:231], v[32:47]
    ds_read_b64_tr_b16 v[16:17], v3 offset:45056
    ds_read_b64_tr_b16 v[18:19], v3 offset:45568
    s_waitcnt lgkmcnt(6)
    v_mfma_f32_32x32x16_bf16 v[48:63], v[20:23], v[228:231], v[48:63]
    s_add_u32 m0, s33, 16384
    ds_read_b64_tr_b16 v[20:21], v3 offset:47104
    ds_read_b64_tr_b16 v[22:23], v3 offset:47616
    buffer_load_dwordx4 v2, s[16:19], s32 offen lds
    s_waitcnt lgkmcnt(6)
    v_mfma_f32_32x32x16_bf16 v[32:47], v[8:11], v[232:235], v[32:47]
    ds_read_b64_tr_b16 v[8:9], v3 offset:49152
    ds_read_b64_tr_b16 v[10:11], v3 offset:49664
    s_waitcnt lgkmcnt(6)
    v_mfma_f32_32x32x16_bf16 v[48:63], v[12:15], v[232:235], v[48:63]
    s_add_u32 m0, s33, 17408
    s_add_u32 s46, s32, s44
    ds_read_b64_tr_b16 v[12:13], v3 offset:51200
    ds_read_b64_tr_b16 v[14:15], v3 offset:51712
    buffer_load_dwordx4 v2, s[16:19], s46 offen lds
    s_add_u32 s32, s32, s45
    s_waitcnt lgkmcnt(6)
    v_mfma_f32_32x32x16_bf16 v[32:47], v[16:19], v[236:239], v[32:47]
    ds_read_b64_tr_b16 v[16:17], v3 offset:53248
    ds_read_b64_tr_b16 v[18:19], v3 offset:53760
    s_waitcnt lgkmcnt(6)
    v_mfma_f32_32x32x16_bf16 v[48:63], v[20:23], v[236:239], v[48:63]
    s_add_u32 m0, s33, 32768
    ds_read_b64_tr_b16 v[20:21], v3 offset:55296
    ds_read_b64_tr_b16 v[22:23], v3 offset:55808
    buffer_load_dwordx4 v2, s[16:19], s32 offen lds
    s_waitcnt lgkmcnt(6)
    v_mfma_f32_32x32x16_bf16 v[32:47], v[8:11], v[240:243], v[32:47]
    ds_read_b64_tr_b16 v[8:9], v3 offset:57344
    ds_read_b64_tr_b16 v[10:11], v3 offset:57856
    s_waitcnt lgkmcnt(6)
    v_mfma_f32_32x32x16_bf16 v[48:63], v[12:15], v[240:243], v[48:63]
    s_add_u32 m0, s33, 33792
    s_add_u32 s46, s32, s44
    ds_read_b64_tr_b16 v[12:13], v3 offset:59392
    ds_read_b64_tr_b16 v[14:15], v3 offset:59904
    buffer_load_dwordx4 v2, s[16:19], s46 offen lds
    s_add_u32 s32, s32, s45
    s_waitcnt lgkmcnt(6)
    v_mfma_f32_32x32x16_bf16 v[32:47], v[16:19], v[244:247], v[32:47]
    ds_read_b64_tr_b16 v[16:17], v3 offset:61440
    ds_read_b64_tr_b16 v[18:19], v3 offset:61952
    s_waitcnt lgkmcnt(6)
    v_mfma_f32_32x32x16_bf16 v[48:63], v[20:23], v[244:247], v[48:63]
    s_add_u32 m0, s33, 49152
    ds_read_b64_tr_b16 v[20:21], v3 offset:63488
    ds_read_b64_tr_b16 v[22:23], v3 offset:64000
    buffer_load_dwordx4 v2, s[16:19], s32 offen lds
    s_waitcnt lgkmcnt(6)
    v_mfma_f32_32x32x16_bf16 v[32:47], v[8:11], v[248:251], v[32:47]
    ds_read_b64_tr_b16 v[8:9], v3 offset:0
    ds_read_b64_tr_b16 v[10:11], v3 offset:512
    s_waitcnt lgkmcnt(6)
    v_mfma_f32_32x32x16_bf16 v[48:63], v[12:15], v[248:251], v[48:63]
    s_add_u32 m0, s33, 50176
    s_add_u32 s46, s32, s44
    ds_read_b64_tr_b16 v[12:13], v3 offset:2048
    ds_read_b64_tr_b16 v[14:15], v3 offset:2560
    buffer_load_dwordx4 v2, s[16:19], s46 offen lds
    s_add_u32 s32, s32, s45
    s_waitcnt lgkmcnt(6)
    v_mfma_f32_32x32x16_bf16 v[32:47], v[16:19], v[252:255], v[32:47]
    ds_read_b64_tr_b16 v[16:17], v3 offset:4096
    ds_read_b64_tr_b16 v[18:19], v3 offset:4608
    s_waitcnt lgkmcnt(6)
    v_mfma_f32_32x32x16_bf16 v[48:63], v[20:23], v[252:255], v[48:63]
    s_mov_b32 s56, s54
    s_mov_b32 s57, s55
    s_mov_b32 s54, s29
    ds_read_b64_tr_b16 v[20:21], v3 offset:6144
    ds_read_b64_tr_b16 v[22:23], v3 offset:6656
    s_waitcnt lgkmcnt(6)
    v_mfma_f32_32x32x16_bf16 v[32:47], v[8:11], v[192:195], v[32:47]
    s_mov_b32 s55, s30
    s_mov_b32 s29, s52
    s_mov_b32 s30, s53
    ds_read_b64_tr_b16 v[8:9], v3 offset:8192
    ds_read_b64_tr_b16 v[10:11], v3 offset:8704
    s_waitcnt lgkmcnt(6)
    v_mfma_f32_32x32x16_bf16 v[48:63], v[12:15], v[192:195], v[48:63]
    s_add_u32 s28, s28, 1
    s_add_u32 s47, s28, 1
    s_lshl_b32 s33, s24, 11
    ds_read_b64_tr_b16 v[12:13], v3 offset:10240
    ds_read_b64_tr_b16 v[14:15], v3 offset:10752
    s_waitcnt lgkmcnt(6)
    v_mfma_f32_32x32x16_bf16 v[32:47], v[16:19], v[196:199], v[32:47]
    s_bitcmp0_b32 s47, 0
    s_cselect_b32 s40, 98304, 0
    s_add_u32 s33, s33, s40
    ds_read_b64_tr_b16 v[16:17], v3 offset:12288
    ds_read_b64_tr_b16 v[18:19], v3 offset:12800
    s_waitcnt lgkmcnt(6)
    v_mfma_f32_32x32x16_bf16 v[48:63], v[20:23], v[196:199], v[48:63]
    s_lshl_b32 s40, s47, 1
    s_mul_i32 s41, s47, 6
    s_lshr_b32 s52, s62, s40
    ds_read_b64_tr_b16 v[20:21], v3 offset:14336
    ds_read_b64_tr_b16 v[22:23], v3 offset:14848
    s_waitcnt lgkmcnt(6)
    v_mfma_f32_32x32x16_bf16 v[32:47], v[8:11], v[200:203], v[32:47]
    s_lshr_b32 s53, s63, s41
    s_and_b32 s52, s52, 3
    s_and_b32 s53, s53, 63
    ds_read_b64_tr_b16 v[8:9], v3 offset:16384
    ds_read_b64_tr_b16 v[10:11], v3 offset:16896
    s_waitcnt lgkmcnt(6)
    v_mfma_f32_32x32x16_bf16 v[48:63], v[12:15], v[200:203], v[48:63]
    s_lshl_b32 s42, s53, 7
    s_and_b32 s40, s52, 1
    s_lshl_b32 s40, s40, 8
    ds_read_b64_tr_b16 v[12:13], v3 offset:18432
    ds_read_b64_tr_b16 v[14:15], v3 offset:18944
    s_waitcnt lgkmcnt(6)
    v_mfma_f32_32x32x16_bf16 v[32:47], v[16:19], v[204:207], v[32:47]
    s_lshr_b32 s41, s24, 1
    s_lshl_b32 s41, s41, 4
    s_add_u32 s40, s40, s41
    ds_read_b64_tr_b16 v[16:17], v3 offset:20480
    ds_read_b64_tr_b16 v[18:19], v3 offset:20992
    s_waitcnt lgkmcnt(6)
    v_mfma_f32_32x32x16_bf16 v[48:63], v[20:23], v[204:207], v[48:63]
    s_lshl_b32 s41, s24, 4
    s_cmp_lt_u32 s52, 2
    s_cselect_b32 s16, s66, s8
    ds_read_b64_tr_b16 v[20:21], v3 offset:22528
    ds_read_b64_tr_b16 v[22:23], v3 offset:23040
    s_waitcnt lgkmcnt(6)
    v_mfma_f32_32x32x16_bf16 v[32:47], v[8:11], v[208:211], v[32:47]
    s_cselect_b32 s17, s67, s9
    s_cselect_b32 s31, 6, 7
    s_cselect_b32 s32, s41, s40
    ds_read_b64_tr_b16 v[8:9], v3 offset:24576
    ds_read_b64_tr_b16 v[10:11], v3 offset:25088
    s_waitcnt lgkmcnt(6)
    v_mfma_f32_32x32x16_bf16 v[48:63], v[12:15], v[208:211], v[48:63]
    s_cselect_b32 s45, 128, 64
    s_lshl_b32 s31, s31, 9
    s_add_u32 s16, s16, s42
    ds_read_b64_tr_b16 v[12:13], v3 offset:26624
    ds_read_b64_tr_b16 v[14:15], v3 offset:27136
    s_waitcnt lgkmcnt(6)
    v_mfma_f32_32x32x16_bf16 v[32:47], v[16:19], v[212:215], v[32:47]
    s_addc_u32 s17, s17, 0
    s_lshl_b32 s18, s31, 9
    s_sub_u32 s18, s18, s42
    ds_read_b64_tr_b16 v[16:17], v3 offset:28672
    ds_read_b64_tr_b16 v[18:19], v3 offset:29184
    s_waitcnt lgkmcnt(6)
    v_mfma_f32_32x32x16_bf16 v[48:63], v[20:23], v[212:215], v[48:63]
    s_mul_i32 s32, s32, s31
    s_mul_i32 s45, s45, s31
    s_lshl_b32 s44, s31, 3
    ds_read_b64_tr_b16 v[20:21], v3 offset:30720
    ds_read_b64_tr_b16 v[22:23], v3 offset:31232
    s_waitcnt lgkmcnt(6)
    v_mfma_f32_32x32x16_bf16 v[32:47], v[8:11], v[216:219], v[32:47]
    v_mad_u32_u24 v2, v6, s31, v7
    s_cmp_lt_u32 s47, 5
    s_cselect_b32 s18, s18, 0
    s_waitcnt lgkmcnt(4)
    v_mfma_f32_32x32x16_bf16 v[48:63], v[12:15], v[216:219], v[48:63]
    s_cmp_lt_u32 s28, 5
    s_cselect_b32 s39, s39, 0
    s_waitcnt lgkmcnt(2)
    v_mfma_f32_32x32x16_bf16 v[32:47], v[16:19], v[220:223], v[32:47]
    s_waitcnt lgkmcnt(0)
    v_mfma_f32_32x32x16_bf16 v[48:63], v[20:23], v[220:223], v[48:63]
    s_branch parallel_sum__mha_block__swiglu_ffn__prompt_kernel_post
.p2align 6
parallel_sum__mha_block__swiglu_ffn__prompt_kernel_post:
    s_nop 7
    s_cmp_eq_u32 s39, 0
    s_cbranch_scc1 parallel_sum__mha_block__swiglu_ffn__prompt_kernel_epi
    s_cmp_lg_u32 s54, 2
    s_cbranch_scc1 parallel_sum__mha_block__swiglu_ffn__prompt_kernel_bar1
parallel_sum__mha_block__swiglu_ffn__prompt_kernel_bar0:
    s_waitcnt vmcnt(5)
    s_branch parallel_sum__mha_block__swiglu_ffn__prompt_kernel_bar
parallel_sum__mha_block__swiglu_ffn__prompt_kernel_bar1:
    s_waitcnt vmcnt(0)
parallel_sum__mha_block__swiglu_ffn__prompt_kernel_bar:
    s_xor_b32 s40, s28, 5
    s_or_b32 s40, s40, s24
    s_cmp_lg_u32 s40, 0
    s_cbranch_scc1 parallel_sum__mha_block__swiglu_ffn__prompt_kernel_q_ok
    v_lshrrev_b32 v90, 4, v0
    v_min_u32 v90, 2, v90
    v_lshlrev_b32 v90, 10, v90
    v_and_b32 v91, 15, v0
    v_lshl_add_u32 v90, v91, 2, v90
    s_and_b32 s40, s2, 7
    s_lshl_b32 s40, s40, 7
    s_add_u32 s40, s40, 20973568
    s_mov_b32 s41, 0x40000
parallel_sum__mha_block__swiglu_ffn__prompt_kernel_q:
    buffer_load_dword v88, v90, s[12:15], s40 offen sc0 sc1
    s_waitcnt vmcnt(0)
    v_cmp_ne_u32 vcc, s84, v88
    s_cmp_eq_u64 vcc, 0
    s_cbranch_scc1 parallel_sum__mha_block__swiglu_ffn__prompt_kernel_q_ok
    s_sleep 2
    s_sub_u32 s41, s41, 1
    s_cmp_lg_u32 s41, 0
    s_cbranch_scc1 parallel_sum__mha_block__swiglu_ffn__prompt_kernel_q
parallel_sum__mha_block__swiglu_ffn__prompt_kernel_q_ok:
    s_barrier
    v_xor_b32 v3, 98304, v3
    ds_read_b64_tr_b16 v[8:9], v3 offset:32768
    ds_read_b64_tr_b16 v[10:11], v3 offset:33280
    ds_read_b64_tr_b16 v[12:13], v3 offset:34816
    ds_read_b64_tr_b16 v[14:15], v3 offset:35328
    ds_read_b64_tr_b16 v[16:17], v3 offset:36864
    ds_read_b64_tr_b16 v[18:19], v3 offset:37376
    s_or_b32 s40, s56, s24
    s_cmp_gt_u32 s40, 1
    s_cselect_b32 s41, 1, s24
    s_cmp_lg_u32 s41, 0
    s_cbranch_scc1 parallel_sum__mha_block__swiglu_ffn__prompt_kernel_nf
    s_lshl_b32 s40, s57, 7
    s_lshl_b32 s41, s25, 2
    s_add_u32 s40, s40, s41
    s_add_u32 s40, s40, 20973568
    v_mov_b32 v88, s84
    v_mov_b32 v89, 0
    s_mov_b64 exec, 1
    buffer_store_dword v88, v89, s[12:15], s40 offen sc0 sc1
    s_mov_b64 exec, -1
parallel_sum__mha_block__swiglu_ffn__prompt_kernel_nf:
    s_cmp_eq_u32 s28, 5
    s_cbranch_scc1 parallel_sum__mha_block__swiglu_ffn__prompt_kernel_p2pre
    s_cmp_eq_u32 s39, 0
    s_cbranch_scc1 parallel_sum__mha_block__swiglu_ffn__prompt_kernel_unit
parallel_sum__mha_block__swiglu_ffn__prompt_kernel_epi:
    s_cmp_eq_u32 s54, 1
    s_cbranch_scc1 parallel_sum__mha_block__swiglu_ffn__prompt_kernel_epiV
    s_cmp_eq_u32 s54, 2
    s_cbranch_scc1 parallel_sum__mha_block__swiglu_ffn__prompt_kernel_epi0
    s_cmp_eq_u32 s54, 3
    s_cbranch_scc1 parallel_sum__mha_block__swiglu_ffn__prompt_kernel_epiG
    s_cmp_lt_u32 s55, 8
    s_cselect_b32 s40, 1052289595, 1.0
    s_lshl_b32 s41, s55, 18
    s_lshl_b32 s42, s27, 10
    s_add_u32 s41, s41, s42
    s_lshl_b32 s42, s49, 17
    s_add_u32 s41, s41, s42
    s_add_u32 s41, s41, 2097152
    v_mul_f32 v32, s40, v32
    v_mul_f32 v33, s40, v33
    v_mul_f32 v34, s40, v34
    v_mul_f32 v35, s40, v35
    v_mul_f32 v36, s40, v36
    v_mul_f32 v37, s40, v37
    v_mul_f32 v38, s40, v38
    v_mul_f32 v39, s40, v39
    v_cvt_pk_bf16_f32 v64, v32, v33
    v_cvt_pk_bf16_f32 v65, v34, v35
    v_cvt_pk_bf16_f32 v66, v36, v37
    v_cvt_pk_bf16_f32 v67, v38, v39
    buffer_store_dwordx4 v[64:67], v1, s[12:15], s41 offen sc0 sc1
    s_add_u32 s41, s41, 65536
    v_mul_f32 v40, s40, v40
    v_mul_f32 v41, s40, v41
    v_mul_f32 v42, s40, v42
    v_mul_f32 v43, s40, v43
    v_mul_f32 v44, s40, v44
    v_mul_f32 v45, s40, v45
    v_mul_f32 v46, s40, v46
    v_mul_f32 v47, s40, v47
    v_cvt_pk_bf16_f32 v68, v40, v41
    v_cvt_pk_bf16_f32 v69, v42, v43
    v_cvt_pk_bf16_f32 v70, v44, v45
    v_cvt_pk_bf16_f32 v71, v46, v47
    buffer_store_dwordx4 v[68:71], v1, s[12:15], s41 offen sc0 sc1
    s_add_u32 s41, s41, 65536
    s_setprio 0
    s_cmp_lg_u32 s39, 0
    s_cbranch_scc1 parallel_sum__mha_block__swiglu_ffn__prompt_kernel_cont
    s_waitcnt vmcnt(2)
    s_branch parallel_sum__mha_block__swiglu_ffn__prompt_kernel_bar
parallel_sum__mha_block__swiglu_ffn__prompt_kernel_epi0:
    s_setprio 0
    s_cmp_lg_u32 s39, 0
    s_cbranch_scc1 parallel_sum__mha_block__swiglu_ffn__prompt_kernel_cont
    s_branch parallel_sum__mha_block__swiglu_ffn__prompt_kernel_bar0
parallel_sum__mha_block__swiglu_ffn__prompt_kernel_epiV:
    s_sub_u32 s41, s55, 16
    s_lshl_b32 s41, s41, 19
    s_lshl_b32 s42, s27, 11
    s_add_u32 s41, s41, s42
    s_lshl_b32 s42, s49, 18
    s_add_u32 s41, s41, s42
    s_add_u32 s41, s41, 6291456
    v_cvt_pk_bf16_f32 v64, v32, v33
    v_cvt_pk_bf16_f32 v65, v34, v35
    v_cvt_pk_bf16_f32 v66, v36, v37
    v_cvt_pk_bf16_f32 v67, v38, v39
    buffer_store_dwordx4 v[64:67], v4, s[12:15], s41 offen offset:0 sc0 sc1
    v_cvt_pk_bf16_f32 v68, v40, v41
    v_cvt_pk_bf16_f32 v69, v42, v43
    v_cvt_pk_bf16_f32 v70, v44, v45
    v_cvt_pk_bf16_f32 v71, v46, v47
    buffer_store_dwordx4 v[68:71], v4, s[12:15], s41 offen offset:1024 sc0 sc1
    s_setprio 0
    s_cmp_lg_u32 s39, 0
    s_cbranch_scc1 parallel_sum__mha_block__swiglu_ffn__prompt_kernel_cont
    s_waitcnt vmcnt(2)
    s_branch parallel_sum__mha_block__swiglu_ffn__prompt_kernel_bar
parallel_sum__mha_block__swiglu_ffn__prompt_kernel_epiG:
    s_mul_i32 s41, s27, 147456
    s_lshl_b32 s42, s55, 12
    s_add_u32 s41, s41, s42
    s_lshl_b32 s42, s49, 11
    s_add_u32 s41, s41, s42
    s_add_u32 s41, s41, 10518528
    s_mov_b32 s40, 3216550459
    v_mul_f32 v64, s40, v32
    v_mul_f32 v65, s40, v33
    v_mul_f32 v66, s40, v34
    v_mul_f32 v67, s40, v35
    v_mul_f32 v68, s40, v36
    v_mul_f32 v69, s40, v37
    v_mul_f32 v70, s40, v38
    v_mul_f32 v71, s40, v39
    v_exp_f32 v64, v64
    v_exp_f32 v65, v65
    v_exp_f32 v66, v66
    v_exp_f32 v67, v67
    v_exp_f32 v68, v68
    v_exp_f32 v69, v69
    v_exp_f32 v70, v70
    v_exp_f32 v71, v71
    v_mul_f32 v32, v32, v48
    v_mul_f32 v33, v33, v49
    v_mul_f32 v34, v34, v50
    v_mul_f32 v35, v35, v51
    v_mul_f32 v36, v36, v52
    v_mul_f32 v37, v37, v53
    v_mul_f32 v38, v38, v54
    v_mul_f32 v39, v39, v55
    v_add_f32 v64, 1.0, v64
    v_add_f32 v65, 1.0, v65
    v_add_f32 v66, 1.0, v66
    v_add_f32 v67, 1.0, v67
    v_add_f32 v68, 1.0, v68
    v_add_f32 v69, 1.0, v69
    v_add_f32 v70, 1.0, v70
    v_add_f32 v71, 1.0, v71
    v_rcp_f32 v64, v64
    v_rcp_f32 v65, v65
    v_rcp_f32 v66, v66
    v_rcp_f32 v67, v67
    v_rcp_f32 v68, v68
    v_rcp_f32 v69, v69
    v_rcp_f32 v70, v70
    v_rcp_f32 v71, v71
    v_mul_f32 v32, v32, v64
    v_mul_f32 v33, v33, v65
    v_mul_f32 v34, v34, v66
    v_mul_f32 v35, v35, v67
    v_mul_f32 v36, v36, v68
    v_mul_f32 v37, v37, v69
    v_mul_f32 v38, v38, v70
    v_mul_f32 v39, v39, v71
    v_cvt_pk_bf16_f32 v80, v32, v33
    v_cvt_pk_bf16_f32 v81, v34, v35
    v_cvt_pk_bf16_f32 v82, v36, v37
    v_cvt_pk_bf16_f32 v83, v38, v39
    buffer_store_dwordx4 v[80:83], v1, s[12:15], s41 offen offset:0 sc0 sc1
    v_mul_f32 v72, s40, v40
    v_mul_f32 v73, s40, v41
    v_mul_f32 v74, s40, v42
    v_mul_f32 v75, s40, v43
    v_mul_f32 v76, s40, v44
    v_mul_f32 v77, s40, v45
    v_mul_f32 v78, s40, v46
    v_mul_f32 v79, s40, v47
    v_exp_f32 v72, v72
    v_exp_f32 v73, v73
    v_exp_f32 v74, v74
    v_exp_f32 v75, v75
    v_exp_f32 v76, v76
    v_exp_f32 v77, v77
    v_exp_f32 v78, v78
    v_exp_f32 v79, v79
    v_mul_f32 v40, v40, v56
    v_mul_f32 v41, v41, v57
    v_mul_f32 v42, v42, v58
    v_mul_f32 v43, v43, v59
    v_mul_f32 v44, v44, v60
    v_mul_f32 v45, v45, v61
    v_mul_f32 v46, v46, v62
    v_mul_f32 v47, v47, v63
    v_add_f32 v72, 1.0, v72
    v_add_f32 v73, 1.0, v73
    v_add_f32 v74, 1.0, v74
    v_add_f32 v75, 1.0, v75
    v_add_f32 v76, 1.0, v76
    v_add_f32 v77, 1.0, v77
    v_add_f32 v78, 1.0, v78
    v_add_f32 v79, 1.0, v79
    v_rcp_f32 v72, v72
    v_rcp_f32 v73, v73
    v_rcp_f32 v74, v74
    v_rcp_f32 v75, v75
    v_rcp_f32 v76, v76
    v_rcp_f32 v77, v77
    v_rcp_f32 v78, v78
    v_rcp_f32 v79, v79
    v_mul_f32 v40, v40, v72
    v_mul_f32 v41, v41, v73
    v_mul_f32 v42, v42, v74
    v_mul_f32 v43, v43, v75
    v_mul_f32 v44, v44, v76
    v_mul_f32 v45, v45, v77
    v_mul_f32 v46, v46, v78
    v_mul_f32 v47, v47, v79
    v_cvt_pk_bf16_f32 v84, v40, v41
    v_cvt_pk_bf16_f32 v85, v42, v43
    v_cvt_pk_bf16_f32 v86, v44, v45
    v_cvt_pk_bf16_f32 v87, v46, v47
    buffer_store_dwordx4 v[84:87], v1, s[12:15], s41 offen offset:1024 sc0 sc1
    s_setprio 0
    s_cmp_lg_u32 s39, 0
    s_cbranch_scc1 parallel_sum__mha_block__swiglu_ffn__prompt_kernel_cont
    s_waitcnt vmcnt(2)
    s_branch parallel_sum__mha_block__swiglu_ffn__prompt_kernel_bar
parallel_sum__mha_block__swiglu_ffn__prompt_kernel_cont:
    s_branch parallel_sum__mha_block__swiglu_ffn__prompt_kernel_unit
parallel_sum__mha_block__swiglu_ffn__prompt_kernel_p2pre:
    s_lshl_b32 s62, s25, 7
    s_lshl_b32 s63, s26, 2
    s_add_u32 s62, s62, s63
    s_add_u32 s62, s62, 20977664
    s_and_b32 s85, s2, 7
    s_lshl_b32 s85, s85, 2
    s_bfe_u32 s86, s2, 0x20003
    s_add_u32 s85, s85, s86
    s_lshr_b32 s87, s2, 5
    s_lshl_b32 s86, s87, 3
    s_add_u32 s86, s86, s24
    s_lshl_b32 s50, s87, 2
    s_lshr_b32 s51, s85, 3
    s_add_u32 s50, s50, s51
    s_and_b32 s51, s85, 7
    s_lshl_b32 s32, s85, 16
    s_lshl_b32 s56, s24, 10
    s_add_u32 s34, s32, s56
    s_add_u32 s34, s34, 4194304
    s_lshl_b32 s35, s34, 1
    s_add_u32 s35, s35, 4292870144
    s_lshl_b32 s60, s24, 11
    s_add_u32 s60, s60, 8192
    s_lshl_b32 s36, s86, 10
    s_add_u32 s36, s36, s32
    s_add_u32 s36, s36, 2097152
    s_waitcnt lgkmcnt(0)
    buffer_load_dwordx4 v[8:11], v1, s[12:15], s36 offen sc0 sc1
    s_mov_b32 s37, s34
    s_mov_b32 s61, s35
    s_mov_b32 s41, 0
    s_add_u32 m0, s41, s56
    s_add_u32 s57, s41, s60
    buffer_load_dwordx4 v1, s[12:15], s37 offen sc0 sc1 lds
    s_mov_b32 m0, s57
    s_add_u32 s37, s37, 8192
    buffer_load_dwordx4 v1, s[12:15], s61 offen sc0 sc1 lds
    buffer_load_dwordx4 v1, s[12:15], s61 offen offset:1024 sc0 sc1 lds
    s_add_u32 s61, s61, 16384
    s_add_u32 s41, s41, 24576
    s_cmp_eq_u32 s41, 73728
    s_cselect_b32 s41, 0, s41
    s_add_u32 m0, s41, s56
    s_add_u32 s57, s41, s60
    buffer_load_dwordx4 v1, s[12:15], s37 offen sc0 sc1 lds
    s_mov_b32 m0, s57
    s_add_u32 s37, s37, 8192
    buffer_load_dwordx4 v1, s[12:15], s61 offen sc0 sc1 lds
    buffer_load_dwordx4 v1, s[12:15], s61 offen offset:1024 sc0 sc1 lds
    s_add_u32 s61, s61, 16384
    s_add_u32 s41, s41, 24576
    s_cmp_eq_u32 s41, 73728
    s_cselect_b32 s41, 0, s41
parallel_sum__mha_block__swiglu_ffn__prompt_kernel_p2:
    v_lshl_add_u32 v4, v6, 10, v7
    v_lshrrev_b32 v5, 5, v0
    v_lshlrev_b32 v5, 2, v5
    v_bfe_u32 v44, v0, 2, 2
    v_add_u32 v5, v5, v44
    v_lshlrev_b32 v5, 7, v5
    v_bfe_u32 v44, v0, 4, 1
    v_lshl_add_u32 v5, v44, 5, v5
    v_and_b32 v44, 3, v0
    v_lshl_add_u32 v5, v44, 3, v5
    v_bfe_u32 v44, v0, 3, 1
    v_lshl_add_u32 v5, v44, 6, v5
    s_lshl_b32 s33, s24, 13
    s_add_u32 s33, s33, 73728
    v_add_u32 v5, s33, v5
    s_mul_i32 s52, s50, 294912
    s_add_u32 s52, s52, 10485760
    s_mul_i32 s53, s24, 14336
    s_add_u32 s53, s53, s52
    s_add_u32 s53, s53, 32768
    s_mul_i32 s54, s24, 229376
    s_lshl_b32 s55, s51, 7
    s_mov_b32 s40, 0
    s_mov_b32 s48, 0
    s_add_u32 s4, s68, s55
    s_addc_u32 s5, s69, 0
    s_sub_u32 s6, 524288, s55
    s_lshl_b32 s7, s24, 16
parallel_sum__mha_block__swiglu_ffn__prompt_kernel_common:
    s_mov_b32 s16, s82
    s_mov_b32 s17, s83
    s_mov_b32 s18, 21004288
    s_mov_b32 s19, 0x00020000
    s_add_u32 s20, s76, s55
    s_addc_u32 s21, s77, 0
    s_mov_b32 s22, 0
    s_mov_b32 s23, 0x00020000
    s_mov_b32 s38, s53
    s_mov_b32 s39, s54
    s_mov_b32 s42, 0
    s_add_u32 m0, s33, s42
    s_add_u32 s58, s39, 8192
    buffer_load_dwordx4 v4, s[20:23], s39 offen lds
    s_add_u32 m0, m0, 1024
    s_add_u32 s39, s39, 16384
    buffer_load_dwordx4 v4, s[20:23], s58 offen lds
    s_add_u32 s42, s42, 2048
    s_and_b32 s42, s42, 0x1fff
    v_mov_b32 v2, v1
    v_add_u32 v3, 24576, v1
    v_mov_b32 v6, v5
    v_xor_b32 v7, 64, v5
    v_mov_b32 v148, 0
    v_mov_b32 v149, 0
    v_mov_b32 v150, 0
    v_mov_b32 v151, 0
    v_mov_b32 v152, 0
    v_mov_b32 v153, 0
    v_mov_b32 v154, 0
    v_mov_b32 v155, 0
    v_mov_b32 v156, 0
    v_mov_b32 v157, 0
    v_mov_b32 v158, 0
    v_mov_b32 v159, 0
    v_mov_b32 v160, 0
    v_mov_b32 v161, 0
    v_mov_b32 v162, 0
    v_mov_b32 v163, 0
    v_mov_b32 v164, 0
    v_mov_b32 v165, 0
    v_mov_b32 v166, 0
    v_mov_b32 v167, 0
    v_mov_b32 v168, 0
    v_mov_b32 v169, 0
    v_mov_b32 v170, 0
    v_mov_b32 v171, 0
    v_mov_b32 v172, 0
    v_mov_b32 v173, 0
    v_mov_b32 v174, 0
    v_mov_b32 v175, 0
    v_mov_b32 v176, 0
    v_mov_b32 v177, 0
    v_mov_b32 v178, 0
    v_mov_b32 v179, 0
    v_mov_b32 v180, 0
    v_mov_b32 v181, 0
    v_mov_b32 v182, 0
    v_mov_b32 v183, 0
    v_mov_b32 v184, 0
    v_mov_b32 v185, 0
    v_mov_b32 v186, 0
    v_mov_b32 v187, 0
    v_mov_b32 v188, 0
    v_mov_b32 v189, 0
    v_mov_b32 v190, 0
    v_mov_b32 v191, 0
    v_mov_b32 v192, 0
    v_mov_b32 v193, 0
    v_mov_b32 v194, 0
    v_mov_b32 v195, 0
    v_mov_b32 v196, 0
    v_mov_b32 v197, 0
    v_mov_b32 v198, 0
    v_mov_b32 v199, 0
    v_mov_b32 v200, 0
    v_mov_b32 v201, 0
    v_mov_b32 v202, 0
    v_mov_b32 v203, 0
    v_mov_b32 v204, 0
    v_mov_b32 v205, 0
    v_mov_b32 v206, 0
    v_mov_b32 v207, 0
    v_mov_b32 v208, 0
    v_mov_b32 v209, 0
    v_mov_b32 v210, 0
    v_mov_b32 v211, 0
    v_mov_b32 v100, 0
    v_mov_b32 v101, 0
    v_mov_b32 v102, 0
    v_mov_b32 v103, 0
    v_mov_b32 v104, 0
    v_mov_b32 v105, 0
    v_mov_b32 v106, 0
    v_mov_b32 v107, 0
    v_mov_b32 v108, 0
    v_mov_b32 v109, 0
    v_mov_b32 v110, 0
    v_mov_b32 v111, 0
    v_mov_b32 v112, 0
    v_mov_b32 v113, 0
    v_mov_b32 v114, 0
    v_mov_b32 v115, 0
    v_mov_b32 v40, 0
    v_mov_b32 v32, 0
    v_mov_b32 v41, 0
    v_mov_b32 v33, 0
    v_mov_b32 v42, 0
    v_mov_b32 v34, 0
    v_mov_b32 v43, 0
    v_mov_b32 v35, 0
    v_mov_b32 v52, 0
    v_mov_b32 v53, 0
    v_mov_b32 v54, 0
    v_mov_b32 v55, 0
    v_mov_b32 v56, 0
    v_mov_b32 v57, 0
    v_mov_b32 v58, 0
    v_mov_b32 v59, 0
    v_mov_b32 v60, 0
    v_mov_b32 v61, 0
    v_mov_b32 v62, 0
    v_mov_b32 v63, 0
    v_mov_b32 v64, 0
    v_mov_b32 v65, 0
    v_mov_b32 v66, 0
    v_mov_b32 v67, 0
    v_mov_b32 v48, 0
    s_lshl_b32 s43, s24, 2
    s_add_u32 s43, s43, 139296
    v_mov_b32 v49, s43
    v_and_b32 v50, 7, v0
    v_lshlrev_b32 v50, 2, v50
    v_add_u32 v50, 139296, v50
    ds_write_b32 v49, v48
    s_waitcnt vmcnt(2) lgkmcnt(0)
    s_barrier
    s_or_b32 s43, s40, s24
    s_cmp_lg_u32 s43, 0
    s_cbranch_scc1 parallel_sum__mha_block__swiglu_ffn__prompt_kernel_nfh
    v_mov_b32 v44, s84
    v_mov_b32 v45, 0
    s_mov_b64 exec, 1
    buffer_store_dword v44, v45, s[12:15], s62 offen sc0 sc1
    s_mov_b64 exec, -1
parallel_sum__mha_block__swiglu_ffn__prompt_kernel_nfh:
    ds_read_b128 v[12:15], v2 offset:0
    ds_read_b128 v[16:19], v2 offset:1024
    ds_read_b128 v[20:23], v2 offset:8192
    ds_read_b128 v[24:27], v2 offset:9216
    s_cmp_eq_u32 s40, 1
    s_cbranch_scc1 parallel_sum__mha_block__swiglu_ffn__prompt_kernel_havemax
    s_waitcnt lgkmcnt(2)
    v_mfma_f32_32x32x16_bf16 v[116:131], v[12:15], v[8:11], 0
    v_mfma_f32_32x32x16_bf16 v[132:147], v[16:19], v[8:11], 0
    s_nop 10
    v_max3_f32 v44, v116, v117, v118
    v_max_f32 v44, v44, v119
    v_max3_f32 v44, v44, v120, v121
    v_max3_f32 v44, v44, v122, v123
    v_max3_f32 v44, v44, v124, v125
    v_max3_f32 v44, v44, v126, v127
    v_max3_f32 v44, v44, v128, v129
    v_max3_f32 v44, v44, v130, v131
    v_max3_f32 v44, v44, v132, v133
    v_max3_f32 v44, v44, v134, v135
    v_max3_f32 v44, v44, v136, v137
    v_max3_f32 v44, v44, v138, v139
    v_max3_f32 v44, v44, v140, v141
    v_max3_f32 v44, v44, v142, v143
    v_max3_f32 v44, v44, v144, v145
    v_max3_f32 v44, v44, v146, v147
    s_mov_b32 s43, 3266314240
    v_mov_b32 v46, v44
    v_mov_b32 v47, v44
    s_nop 1
    v_permlane32_swap_b32 v46, v47
    v_max_f32 v46, v46, v47
    v_sub_f32 v46, s43, v46
    v_mov_b32 v84, v46
    v_mov_b32 v85, v46
    v_mov_b32 v86, v46
    v_mov_b32 v87, v46
    v_mov_b32 v88, v46
    v_mov_b32 v89, v46
    v_mov_b32 v90, v46
    v_mov_b32 v91, v46
    v_mov_b32 v92, v46
    v_mov_b32 v93, v46
    v_mov_b32 v94, v46
    v_mov_b32 v95, v46
    v_mov_b32 v96, v46
    v_mov_b32 v97, v46
    v_mov_b32 v98, v46
    v_mov_b32 v99, v46
parallel_sum__mha_block__swiglu_ffn__prompt_kernel_havemax:
    s_add_u32 m0, s33, s42
    s_add_u32 s58, s39, 8192
    buffer_load_dwordx4 v4, s[20:23], s39 offen lds
    s_add_u32 m0, m0, 1024
    s_add_u32 s39, s39, 16384
    buffer_load_dwordx4 v4, s[20:23], s58 offen lds
    s_add_u32 s42, s42, 2048
    s_and_b32 s42, s42, 0x1fff
    s_mov_b32 s39, s54
    s_sub_u32 s22, 1835008, s55
    s_waitcnt vmcnt(0)
    ds_read_b64_tr_b16 v[68:69], v6 offset:0
    ds_read_b64_tr_b16 v[70:71], v6 offset:1024
    ds_read_b64_tr_b16 v[72:73], v7 offset:0
    ds_read_b64_tr_b16 v[74:75], v7 offset:1024
    s_waitcnt lgkmcnt(0)
    v_mfma_f32_32x32x16_bf16 v[116:131], v[12:15], v[8:11], v[84:99]
    s_mov_b32 s44, 0
    s_mov_b32 s45, 24576
    s_nop 7
    s_nop 1
.p2align 6
parallel_sum__mha_block__swiglu_ffn__prompt_kernel_loop:
    v_add_u32 v48, 1, v48
    s_waitcnt vmcnt(4)
    ds_write_b32 v49, v48
    s_setprio 3
    v_exp_f32 v116, v116
    v_exp_f32 v117, v117
    v_mfma_f32_32x32x16_bf16 v[100:115], v[32:35], v[40:43], v[100:115]
    ds_read_b128 v[12:15], v2 offset:2048
    v_exp_f32 v118, v118
    v_exp_f32 v119, v119
    v_exp_f32 v120, v120
    v_exp_f32 v121, v121
    v_mfma_f32_32x32x16_bf16 v[132:147], v[16:19], v[8:11], v[84:99]
    ds_read_b128 v[28:31], v2 offset:10240
    v_exp_f32 v122, v122
    v_exp_f32 v123, v123
    s_cmp_eq_u32 s44, 7
    s_cselect_b32 s18, 0, s18
    v_exp_f32 v124, v124
    v_exp_f32 v125, v125
    v_cvt_pk_bf16_f32 v36, v116, v117
    v_cvt_pk_bf16_f32 v37, v118, v119
    v_cvt_pk_bf16_f32 v38, v120, v121
    v_cvt_pk_bf16_f32 v39, v122, v123
    s_waitcnt vmcnt(7)
    v_mfma_f32_32x32x16_bf16 v[148:163], v[68:71], v[52:55], v[148:163]
    s_cselect_b32 s20, s4, s20
    s_cselect_b32 s21, s5, s21
    v_exp_f32 v126, v126
    v_exp_f32 v127, v127
    s_cselect_b32 s22, s6, s22
    s_cselect_b32 s39, s7, s39
    v_exp_f32 v128, v128
    s_waitcnt lgkmcnt(1)
    v_mfma_f32_32x32x16_bf16 v[100:115], v[20:23], v[36:39], v[100:115]
    ds_read_b128 v[32:35], v2 offset:11264
    v_exp_f32 v129, v129
    v_exp_f32 v130, v130
    v_exp_f32 v131, v131
    v_cvt_pk_bf16_f32 v40, v124, v125
    v_cvt_pk_bf16_f32 v41, v126, v127
    v_cvt_pk_bf16_f32 v42, v128, v129
    v_cvt_pk_bf16_f32 v43, v130, v131
    v_exp_f32 v132, v132
    v_exp_f32 v133, v133
    v_mfma_f32_32x32x16_bf16 v[100:115], v[24:27], v[40:43], v[100:115]
    ds_read_b128 v[16:19], v2 offset:3072
    v_exp_f32 v134, v134
    v_exp_f32 v135, v135
    s_add_u32 m0, s33, s42
    s_add_u32 s58, s39, 8192
    v_exp_f32 v136, v136
    v_exp_f32 v137, v137
    v_mfma_f32_32x32x16_bf16 v[116:131], v[12:15], v[8:11], v[84:99]
    ds_read_b128 v[20:23], v2 offset:12288
    v_exp_f32 v138, v138
    v_exp_f32 v139, v139
    buffer_load_dwordx4 v4, s[20:23], s39 offen lds
    v_exp_f32 v140, v140
    v_exp_f32 v141, v141
    s_add_u32 m0, m0, 1024
    s_add_u32 s39, s39, 16384
    v_cvt_pk_bf16_f32 v36, v132, v133
    v_cvt_pk_bf16_f32 v37, v134, v135
    v_cvt_pk_bf16_f32 v38, v136, v137
    v_cvt_pk_bf16_f32 v39, v138, v139
    v_mfma_f32_32x32x16_bf16 v[164:179], v[68:71], v[56:59], v[164:179]
    buffer_load_dwordx4 v4, s[20:23], s58 offen lds
    v_exp_f32 v142, v142
    v_exp_f32 v143, v143
    s_add_u32 s42, s42, 2048
    s_and_b32 s42, s42, 0x1fff
    v_exp_f32 v144, v144
    s_waitcnt lgkmcnt(1)
    v_mfma_f32_32x32x16_bf16 v[100:115], v[28:31], v[36:39], v[100:115]
    ds_read_b128 v[24:27], v2 offset:13312
    v_exp_f32 v145, v145
    v_exp_f32 v146, v146
    v_exp_f32 v147, v147
    v_cvt_pk_bf16_f32 v40, v140, v141
    v_cvt_pk_bf16_f32 v41, v142, v143
    v_cvt_pk_bf16_f32 v42, v144, v145
    v_cvt_pk_bf16_f32 v43, v146, v147
    s_setprio 2
    v_exp_f32 v116, v116
    v_exp_f32 v117, v117
    v_mfma_f32_32x32x16_bf16 v[100:115], v[32:35], v[40:43], v[100:115]
    ds_read_b128 v[12:15], v2 offset:4096
    v_exp_f32 v118, v118
    v_exp_f32 v119, v119
    s_waitcnt vmcnt(4)
    v_exp_f32 v120, v120
    v_exp_f32 v121, v121
    v_mfma_f32_32x32x16_bf16 v[132:147], v[16:19], v[8:11], v[84:99]
    ds_read_b128 v[28:31], v2 offset:14336
    v_exp_f32 v122, v122
    v_exp_f32 v123, v123
    ds_read_b64_tr_b16 v[76:77], v6 offset:2048
    v_exp_f32 v124, v124
    v_exp_f32 v125, v125
    ds_read_b64_tr_b16 v[78:79], v6 offset:3072
    v_cvt_pk_bf16_f32 v36, v116, v117
    v_cvt_pk_bf16_f32 v37, v118, v119
    v_cvt_pk_bf16_f32 v38, v120, v121
    v_cvt_pk_bf16_f32 v39, v122, v123
    v_mfma_f32_32x32x16_bf16 v[180:195], v[72:75], v[52:55], v[180:195]
    ds_read_b64_tr_b16 v[80:81], v7 offset:2048
    v_exp_f32 v126, v126
    v_exp_f32 v127, v127
    ds_read_b64_tr_b16 v[82:83], v7 offset:3072
    v_exp_f32 v128, v128
    s_waitcnt lgkmcnt(5)
    v_mfma_f32_32x32x16_bf16 v[100:115], v[20:23], v[36:39], v[100:115]
    ds_read_b128 v[32:35], v2 offset:15360
    v_exp_f32 v129, v129
    v_exp_f32 v130, v130
    v_exp_f32 v131, v131
    v_cvt_pk_bf16_f32 v40, v124, v125
    v_cvt_pk_bf16_f32 v41, v126, v127
    v_cvt_pk_bf16_f32 v42, v128, v129
    v_cvt_pk_bf16_f32 v43, v130, v131
    v_exp_f32 v132, v132
    v_exp_f32 v133, v133
    v_mfma_f32_32x32x16_bf16 v[100:115], v[24:27], v[40:43], v[100:115]
    ds_read_b128 v[16:19], v2 offset:5120
    v_exp_f32 v134, v134
    v_exp_f32 v135, v135
    v_exp_f32 v136, v136
    v_exp_f32 v137, v137
    v_mfma_f32_32x32x16_bf16 v[116:131], v[12:15], v[8:11], v[84:99]
    ds_read_b128 v[20:23], v2 offset:16384
    v_exp_f32 v138, v138
    v_exp_f32 v139, v139
    v_exp_f32 v140, v140
    v_exp_f32 v141, v141
    v_cvt_pk_bf16_f32 v36, v132, v133
    v_cvt_pk_bf16_f32 v37, v134, v135
    v_cvt_pk_bf16_f32 v38, v136, v137
    v_cvt_pk_bf16_f32 v39, v138, v139
    v_mfma_f32_32x32x16_bf16 v[196:211], v[72:75], v[56:59], v[196:211]
    ds_read_b32 v51, v50
    v_exp_f32 v142, v142
    v_exp_f32 v143, v143
    v_exp_f32 v144, v144
    s_waitcnt lgkmcnt(2)
    v_mfma_f32_32x32x16_bf16 v[100:115], v[28:31], v[36:39], v[100:115]
    ds_read_b128 v[24:27], v2 offset:17408
    v_exp_f32 v145, v145
    v_exp_f32 v146, v146
    v_exp_f32 v147, v147
    v_cvt_pk_bf16_f32 v40, v140, v141
    v_cvt_pk_bf16_f32 v41, v142, v143
    v_cvt_pk_bf16_f32 v42, v144, v145
    v_cvt_pk_bf16_f32 v43, v146, v147
    s_setprio 1
    v_exp_f32 v116, v116
    v_exp_f32 v117, v117
    v_mfma_f32_32x32x16_bf16 v[100:115], v[32:35], v[40:43], v[100:115]
    ds_read_b128 v[12:15], v2 offset:6144
    v_exp_f32 v118, v118
    v_exp_f32 v119, v119
    s_or_b32 s59, s44, s40
    s_cmp_eq_u32 s59, 0
    s_cbranch_scc1 parallel_sum__mha_block__swiglu_ffn__prompt_kernel_h
parallel_sum__mha_block__swiglu_ffn__prompt_kernel_h_ok:
    v_exp_f32 v120, v120
    v_exp_f32 v121, v121
    v_mfma_f32_32x32x16_bf16 v[132:147], v[16:19], v[8:11], v[84:99]
    ds_read_b128 v[28:31], v2 offset:18432
    v_exp_f32 v122, v122
    v_exp_f32 v123, v123
    buffer_load_dwordx4 v[52:55], v1, s[16:19], s38 offen sc0 sc1
    v_exp_f32 v124, v124
    v_exp_f32 v125, v125
    s_add_u32 s59, s38, 147456
    s_add_u32 s38, s38, 1024
    v_cvt_pk_bf16_f32 v36, v116, v117
    v_cvt_pk_bf16_f32 v37, v118, v119
    v_cvt_pk_bf16_f32 v38, v120, v121
    v_cvt_pk_bf16_f32 v39, v122, v123
    s_waitcnt vmcnt(3)
    v_mfma_f32_32x32x16_bf16 v[148:163], v[76:79], v[60:63], v[148:163]
    buffer_load_dwordx4 v[56:59], v1, s[16:19], s59 offen sc0 sc1
    v_exp_f32 v126, v126
    v_exp_f32 v127, v127
    v_exp_f32 v128, v128
    s_waitcnt lgkmcnt(1)
    v_mfma_f32_32x32x16_bf16 v[100:115], v[20:23], v[36:39], v[100:115]
    ds_read_b128 v[32:35], v2 offset:19456
    v_exp_f32 v129, v129
    v_exp_f32 v130, v130
    v_cmp_lt_u32 vcc, v51, v48
    s_cmp_lg_u64 vcc, 0
    s_cbranch_scc1 parallel_sum__mha_block__swiglu_ffn__prompt_kernel_sq
parallel_sum__mha_block__swiglu_ffn__prompt_kernel_sq_ok:
    v_exp_f32 v131, v131
    v_cvt_pk_bf16_f32 v40, v124, v125
    v_cvt_pk_bf16_f32 v41, v126, v127
    v_cvt_pk_bf16_f32 v42, v128, v129
    v_cvt_pk_bf16_f32 v43, v130, v131
    v_exp_f32 v132, v132
    v_exp_f32 v133, v133
    v_mfma_f32_32x32x16_bf16 v[100:115], v[24:27], v[40:43], v[100:115]
    ds_read_b128 v[16:19], v2 offset:7168
    v_exp_f32 v134, v134
    v_exp_f32 v135, v135
    s_add_u32 m0, s41, s56
    s_add_u32 s57, s41, s60
    v_exp_f32 v136, v136
    v_exp_f32 v137, v137
    v_mfma_f32_32x32x16_bf16 v[116:131], v[12:15], v[8:11], v[84:99]
    ds_read_b128 v[20:23], v2 offset:20480
    v_exp_f32 v138, v138
    buffer_load_dwordx4 v1, s[12:15], s37 offen sc0 sc1 lds
    v_exp_f32 v139, v139
    v_exp_f32 v140, v140
    s_mov_b32 m0, s57
    s_add_u32 s37, s37, 8192
    v_exp_f32 v141, v141
    v_cvt_pk_bf16_f32 v36, v132, v133
    v_cvt_pk_bf16_f32 v37, v134, v135
    v_cvt_pk_bf16_f32 v38, v136, v137
    v_cvt_pk_bf16_f32 v39, v138, v139
    v_mfma_f32_32x32x16_bf16 v[164:179], v[76:79], v[64:67], v[164:179]
    buffer_load_dwordx4 v1, s[12:15], s61 offen sc0 sc1 lds
    v_exp_f32 v142, v142
    v_exp_f32 v143, v143
    buffer_load_dwordx4 v1, s[12:15], s61 offen offset:1024 sc0 sc1 lds
    v_exp_f32 v144, v144
    s_waitcnt lgkmcnt(1)
    v_mfma_f32_32x32x16_bf16 v[100:115], v[28:31], v[36:39], v[100:115]
    ds_read_b128 v[24:27], v2 offset:21504
    v_exp_f32 v145, v145
    s_add_u32 s61, s61, 16384
    s_add_u32 s41, s41, 24576
    v_exp_f32 v146, v146
    v_exp_f32 v147, v147
    s_cmp_eq_u32 s41, 73728
    s_cselect_b32 s41, 0, s41
    v_cvt_pk_bf16_f32 v40, v140, v141
    v_cvt_pk_bf16_f32 v41, v142, v143
    v_cvt_pk_bf16_f32 v42, v144, v145
    v_cvt_pk_bf16_f32 v43, v146, v147
    v_xor_b32 v6, 0x1000, v6
    v_xor_b32 v7, 0x1000, v7
    s_setprio 0
    v_exp_f32 v116, v116
    v_exp_f32 v117, v117
    v_mfma_f32_32x32x16_bf16 v[100:115], v[32:35], v[40:43], v[100:115]
    ds_read_b128 v[12:15], v3 offset:0
    v_exp_f32 v118, v118
    v_exp_f32 v119, v119
    s_waitcnt vmcnt(5)
    v_exp_f32 v120, v120
    v_exp_f32 v121, v121
    v_mfma_f32_32x32x16_bf16 v[132:147], v[16:19], v[8:11], v[84:99]
    ds_read_b128 v[28:31], v2 offset:22528
    v_exp_f32 v122, v122
    v_exp_f32 v123, v123
    ds_read_b64_tr_b16 v[68:69], v6 offset:0
    v_exp_f32 v124, v124
    v_exp_f32 v125, v125
    ds_read_b64_tr_b16 v[70:71], v6 offset:1024
    v_cvt_pk_bf16_f32 v36, v116, v117
    v_cvt_pk_bf16_f32 v37, v118, v119
    v_cvt_pk_bf16_f32 v38, v120, v121
    v_cvt_pk_bf16_f32 v39, v122, v123
    v_mfma_f32_32x32x16_bf16 v[180:195], v[80:83], v[60:63], v[180:195]
    ds_read_b64_tr_b16 v[72:73], v7 offset:0
    v_exp_f32 v126, v126
    v_exp_f32 v127, v127
    ds_read_b64_tr_b16 v[74:75], v7 offset:1024
    v_exp_f32 v128, v128
    s_waitcnt lgkmcnt(5)
    v_mfma_f32_32x32x16_bf16 v[100:115], v[20:23], v[36:39], v[100:115]
    ds_read_b128 v[32:35], v2 offset:23552
    v_exp_f32 v129, v129
    v_exp_f32 v130, v130
    v_exp_f32 v131, v131
    v_cvt_pk_bf16_f32 v40, v124, v125
    v_cvt_pk_bf16_f32 v41, v126, v127
    v_cvt_pk_bf16_f32 v42, v128, v129
    v_cvt_pk_bf16_f32 v43, v130, v131
    v_exp_f32 v132, v132
    v_exp_f32 v133, v133
    v_mfma_f32_32x32x16_bf16 v[100:115], v[24:27], v[40:43], v[100:115]
    ds_read_b128 v[16:19], v3 offset:1024
    v_exp_f32 v134, v134
    v_exp_f32 v135, v135
    s_add_u32 m0, s33, s42
    s_add_u32 s58, s39, 8192
    v_exp_f32 v136, v136
    v_exp_f32 v137, v137
    v_mfma_f32_32x32x16_bf16 v[116:131], v[12:15], v[8:11], v[84:99]
    ds_read_b128 v[20:23], v3 offset:8192
    v_exp_f32 v138, v138
    v_exp_f32 v139, v139
    buffer_load_dwordx4 v4, s[20:23], s39 offen lds
    v_exp_f32 v140, v140
    v_exp_f32 v141, v141
    s_add_u32 m0, m0, 1024
    s_add_u32 s39, s39, 16384
    v_cvt_pk_bf16_f32 v36, v132, v133
    v_cvt_pk_bf16_f32 v37, v134, v135
    v_cvt_pk_bf16_f32 v38, v136, v137
    v_cvt_pk_bf16_f32 v39, v138, v139
    v_mfma_f32_32x32x16_bf16 v[196:211], v[80:83], v[64:67], v[196:211]
    buffer_load_dwordx4 v4, s[20:23], s58 offen lds
    v_exp_f32 v142, v142
    v_exp_f32 v143, v143
    s_add_u32 s42, s42, 2048
    s_and_b32 s42, s42, 0x1fff
    v_exp_f32 v144, v144
    s_waitcnt lgkmcnt(1)
    v_mfma_f32_32x32x16_bf16 v[100:115], v[28:31], v[36:39], v[100:115]
    ds_read_b128 v[24:27], v3 offset:9216
    v_exp_f32 v145, v145
    v_exp_f32 v146, v146
    v_exp_f32 v147, v147
    v_cvt_pk_bf16_f32 v40, v140, v141
    v_cvt_pk_bf16_f32 v41, v142, v143
    v_cvt_pk_bf16_f32 v42, v144, v145
    v_cvt_pk_bf16_f32 v43, v146, v147
    buffer_load_dwordx4 v[60:63], v1, s[16:19], s38 offen sc0 sc1
    s_add_u32 s59, s38, 147456
    s_add_u32 s38, s38, 1024
    buffer_load_dwordx4 v[64:67], v1, s[16:19], s59 offen sc0 sc1
    v_mov_b32 v2, v3
    s_add_u32 s45, s45, 24576
    s_cmp_eq_u32 s45, 73728
    s_cselect_b32 s45, 0, s45
    v_add_u32 v3, s45, v1
    s_add_u32 s44, s44, 1
    s_cmp_lg_u32 s44, 8
    s_cbranch_scc1 parallel_sum__mha_block__swiglu_ffn__prompt_kernel_loop
    s_setprio 0
    v_mfma_f32_32x32x16_bf16 v[100:115], v[32:35], v[40:43], v[100:115]
    s_mul_i32 s43, s86, 147456
    s_lshl_b32 s44, s85, 10
    s_add_u32 s43, s43, s44
    s_add_u32 s43, s43, 10485760
    s_mov_b32 s45, 1904214016
    v_mov_b32 v45, 0x207
    s_nop 5
    v_rcp_f32 v44, v108
    v_cmp_ngt_f32 s[46:47], s45, v108
    v_cmp_class_f32 vcc, v100, v45
    v_mul_f32 v100, v100, v44
    s_or_b64 s[46:47], s[46:47], vcc
    v_cmp_class_f32 vcc, v101, v45
    v_mul_f32 v101, v101, v44
    s_or_b64 s[46:47], s[46:47], vcc
    v_cmp_class_f32 vcc, v102, v45
    v_mul_f32 v102, v102, v44
    s_or_b64 s[46:47], s[46:47], vcc
    v_cmp_class_f32 vcc, v103, v45
    v_mul_f32 v103, v103, v44
    s_or_b64 s[46:47], s[46:47], vcc
    v_cmp_class_f32 vcc, v104, v45
    v_mul_f32 v104, v104, v44
    s_or_b64 s[46:47], s[46:47], vcc
    v_cmp_class_f32 vcc, v105, v45
    v_mul_f32 v105, v105, v44
    s_or_b64 s[46:47], s[46:47], vcc
    v_cmp_class_f32 vcc, v106, v45
    v_mul_f32 v106, v106, v44
    s_or_b64 s[46:47], s[46:47], vcc
    v_cmp_class_f32 vcc, v107, v45
    v_mul_f32 v107, v107, v44
    s_or_b64 s[46:47], s[46:47], vcc
    v_cvt_pk_bf16_f32 v36, v100, v101
    v_cvt_pk_bf16_f32 v37, v102, v103
    v_cvt_pk_bf16_f32 v38, v104, v105
    v_cvt_pk_bf16_f32 v39, v106, v107
    s_cmp_lg_u32 s48, 0
    s_cbranch_scc1 parallel_sum__mha_block__swiglu_ffn__prompt_kernel_nost
    buffer_store_dwordx4 v[36:39], v1, s[12:15], s43 offen sc0 sc1
parallel_sum__mha_block__swiglu_ffn__prompt_kernel_nost:
    s_add_u32 m0, s33, s42
    s_add_u32 s58, s39, 8192
    buffer_load_dwordx4 v4, s[20:23], s39 offen lds
    s_add_u32 m0, m0, 1024
    s_add_u32 s39, s39, 16384
    buffer_load_dwordx4 v4, s[20:23], s58 offen lds
    s_add_u32 s42, s42, 2048
    s_and_b32 s42, s42, 0x1fff
    s_add_u32 m0, s33, s42
    s_add_u32 s58, s39, 8192
    buffer_load_dwordx4 v4, s[20:23], s39 offen lds
    s_add_u32 m0, m0, 1024
    s_add_u32 s39, s39, 16384
    buffer_load_dwordx4 v4, s[20:23], s58 offen lds
    s_add_u32 s42, s42, 2048
    s_and_b32 s42, s42, 0x1fff
    s_cmp_lg_u64 s[46:47], 0
    s_cselect_b32 s43, 1, 0
    s_andn2_b32 s43, s43, s40
    s_mov_b32 s46, s43
    v_mov_b32 v44, s43
    s_lshl_b32 s43, s24, 2
    s_add_u32 s43, s43, 139264
    v_mov_b32 v45, s43
    ds_write_b32 v45, v44
    s_lshl_b32 s44, s50, 16
    s_bfe_u32 s45, s24, 0x10001
    s_lshl_b32 s45, s45, 15
    s_add_u32 s44, s44, s45
    s_lshr_b32 s45, s24, 2
    s_lshl_b32 s45, s45, 6
    s_add_u32 s44, s44, s45
    s_and_b32 s45, s24, 1
    s_lshl_b32 s45, s45, 5
    s_add_u32 s44, s44, s45
    s_add_u32 s44, s44, s55
    v_and_b32 v2, 31, v0
    v_lshlrev_b32 v2, 10, v2
    v_lshrrev_b32 v46, 5, v0
    v_lshl_add_u32 v2, v46, 3, v2
    s_mov_b32 s28, s64
    s_mov_b32 s29, s65
    s_mov_b32 s30, 2097152
    s_mov_b32 s31, 0x00020000
    buffer_load_dwordx2 v[12:13], v2, s[28:31], s44 offen
    buffer_load_dwordx2 v[14:15], v2, s[28:31], s44 offen offset:16
    v_and_b32 v47, 7, v0
    v_lshlrev_b32 v47, 2, v47
    v_add_u32 v47, 139264, v47
    s_waitcnt vmcnt(6) lgkmcnt(0)
    s_cmp_lg_u32 s46, 0
    s_cbranch_scc1 parallel_sum__mha_block__swiglu_ffn__prompt_kernel_nfo
    s_lshl_b32 s43, s86, 7
    s_lshl_b32 s45, s85, 2
    s_add_u32 s43, s43, s45
    s_add_u32 s43, s43, 20979712
    s_mov_b32 s48, 1
    v_mov_b32 v44, s84
    v_mov_b32 v45, 0
    s_mov_b64 exec, 1
    buffer_store_dword v44, v45, s[12:15], s43 offen sc0 sc1
    s_mov_b64 exec, -1
parallel_sum__mha_block__swiglu_ffn__prompt_kernel_nfo:
    s_barrier
    ds_read_b32 v44, v47
    s_waitcnt lgkmcnt(0)
    v_cmp_ne_u32 vcc, 0, v44
    s_cmp_eq_u64 vcc, 0
    s_cbranch_scc0 parallel_sum__mha_block__swiglu_ffn__prompt_kernel_fb
parallel_sum__mha_block__swiglu_ffn__prompt_kernel_good:
    s_cmp_lg_u32 s24, 0
    s_cbranch_scc1 parallel_sum__mha_block__swiglu_ffn__prompt_kernel_o_ok
    s_lshl_b32 s43, s50, 8
    s_add_u32 s43, s43, 20979712
    v_lshlrev_b32 v46, 2, v0
    v_and_b32 v47, 31, v0
    v_cmp_ne_u32 s[46:47], s85, v47
    s_mov_b64 exec, s[46:47]
    s_mov_b32 s45, 0x40000
parallel_sum__mha_block__swiglu_ffn__prompt_kernel_op:
    buffer_load_dword v44, v46, s[12:15], s43 offen sc0 sc1
    s_waitcnt vmcnt(0)
    v_cmp_ne_u32 vcc, s84, v44
    s_cmp_eq_u64 vcc, 0
    s_cbranch_scc1 parallel_sum__mha_block__swiglu_ffn__prompt_kernel_op_ok
    s_sleep 2
    s_sub_u32 s45, s45, 1
    s_cmp_lg_u32 s45, 0
    s_cbranch_scc1 parallel_sum__mha_block__swiglu_ffn__prompt_kernel_op
parallel_sum__mha_block__swiglu_ffn__prompt_kernel_op_ok:
    s_mov_b64 exec, -1
parallel_sum__mha_block__swiglu_ffn__prompt_kernel_o_ok:
    v_xor_b32 v7, 64, v5
    s_waitcnt vmcnt(0)
    ds_read_b64_tr_b16 v[84:85], v5 offset:0
    ds_read_b64_tr_b16 v[86:87], v5 offset:1024
    ds_read_b64_tr_b16 v[88:89], v7 offset:0
    ds_read_b64_tr_b16 v[90:91], v7 offset:1024
    ds_read_b64_tr_b16 v[92:93], v5 offset:2048
    ds_read_b64_tr_b16 v[94:95], v5 offset:3072
    ds_read_b64_tr_b16 v[96:97], v7 offset:2048
    ds_read_b64_tr_b16 v[98:99], v7 offset:3072
    ds_read_b64_tr_b16 v[100:101], v5 offset:4096
    ds_read_b64_tr_b16 v[102:103], v5 offset:5120
    ds_read_b64_tr_b16 v[104:105], v7 offset:4096
    ds_read_b64_tr_b16 v[106:107], v7 offset:5120
    ds_read_b64_tr_b16 v[108:109], v5 offset:6144
    ds_read_b64_tr_b16 v[110:111], v5 offset:7168
    ds_read_b64_tr_b16 v[112:113], v7 offset:6144
    ds_read_b64_tr_b16 v[114:115], v7 offset:7168
    s_waitcnt lgkmcnt(0)
    s_barrier
    s_lshl_b32 s43, s24, 12
    s_add_u32 s43, s43, s52
    s_add_u32 s45, s43, 147456
    buffer_load_dwordx4 v[116:119], v1, s[12:15], s43 offen offset:0 sc0 sc1
    buffer_load_dwordx4 v[120:123], v1, s[12:15], s45 offen offset:0 sc0 sc1
    buffer_load_dwordx4 v[124:127], v1, s[12:15], s43 offen offset:1024 sc0 sc1
    buffer_load_dwordx4 v[128:131], v1, s[12:15], s45 offen offset:1024 sc0 sc1
    buffer_load_dwordx4 v[132:135], v1, s[12:15], s43 offen offset:2048 sc0 sc1
    buffer_load_dwordx4 v[136:139], v1, s[12:15], s45 offen offset:2048 sc0 sc1
    buffer_load_dwordx4 v[140:143], v1, s[12:15], s43 offen offset:3072 sc0 sc1
    buffer_load_dwordx4 v[144:147], v1, s[12:15], s45 offen offset:3072 sc0 sc1
    s_lshl_b32 s45, s24, 14
    v_add_u32 v44, s45, v1
    s_waitcnt vmcnt(6)
    v_mfma_f32_32x32x16_bf16 v[148:163], v[84:87], v[116:119], v[148:163]
    v_mfma_f32_32x32x16_bf16 v[164:179], v[84:87], v[120:123], v[164:179]
    v_mfma_f32_32x32x16_bf16 v[180:195], v[88:91], v[116:119], v[180:195]
    v_mfma_f32_32x32x16_bf16 v[196:211], v[88:91], v[120:123], v[196:211]
    s_waitcnt vmcnt(4)
    v_mfma_f32_32x32x16_bf16 v[148:163], v[92:95], v[124:127], v[148:163]
    v_mfma_f32_32x32x16_bf16 v[164:179], v[92:95], v[128:131], v[164:179]
    v_mfma_f32_32x32x16_bf16 v[180:195], v[96:99], v[124:127], v[180:195]
    v_mfma_f32_32x32x16_bf16 v[196:211], v[96:99], v[128:131], v[196:211]
    s_waitcnt vmcnt(2)
    v_mfma_f32_32x32x16_bf16 v[148:163], v[100:103], v[132:135], v[148:163]
    v_mfma_f32_32x32x16_bf16 v[164:179], v[100:103], v[136:139], v[164:179]
    v_mfma_f32_32x32x16_bf16 v[180:195], v[104:107], v[132:135], v[180:195]
    v_mfma_f32_32x32x16_bf16 v[196:211], v[104:107], v[136:139], v[196:211]
    s_waitcnt vmcnt(0)
    v_mfma_f32_32x32x16_bf16 v[148:163], v[108:111], v[140:143], v[148:163]
    v_mfma_f32_32x32x16_bf16 v[164:179], v[108:111], v[144:147], v[164:179]
    v_mfma_f32_32x32x16_bf16 v[180:195], v[112:115], v[140:143], v[180:195]
    v_mfma_f32_32x32x16_bf16 v[196:211], v[112:115], v[144:147], v[196:211]
    s_nop 8
    ds_write_b128 v44, v[148:151] offset:0
    ds_write_b128 v44, v[152:155] offset:1024
    ds_write_b128 v44, v[156:159] offset:2048
    ds_write_b128 v44, v[160:163] offset:3072
    ds_write_b128 v44, v[164:167] offset:4096
    ds_write_b128 v44, v[168:171] offset:5120
    ds_write_b128 v44, v[172:175] offset:6144
    ds_write_b128 v44, v[176:179] offset:7168
    ds_write_b128 v44, v[180:183] offset:8192
    ds_write_b128 v44, v[184:187] offset:9216
    ds_write_b128 v44, v[188:191] offset:10240
    ds_write_b128 v44, v[192:195] offset:11264
    ds_write_b128 v44, v[196:199] offset:12288
    ds_write_b128 v44, v[200:203] offset:13312
    ds_write_b128 v44, v[204:207] offset:14336
    ds_write_b128 v44, v[208:211] offset:15360
    s_lshl_b32 s45, s24, 11
    v_add_u32 v44, s45, v1
    v_add_u32 v45, 0x10000, v44
    v_lshlrev_b32 v116, 16, v12
    v_and_b32 v117, 0xffff0000, v12
    v_lshlrev_b32 v118, 16, v13
    v_and_b32 v119, 0xffff0000, v13
    v_lshlrev_b32 v120, 16, v14
    v_and_b32 v121, 0xffff0000, v14
    v_lshlrev_b32 v122, 16, v15
    v_and_b32 v123, 0xffff0000, v15
    s_mov_b32 s28, s78
    s_mov_b32 s29, s79
    s_mov_b32 s30, 2097152
    s_mov_b32 s31, 0x00020000
    s_waitcnt lgkmcnt(0)
    s_barrier
    ds_read_b128 v[148:151], v44 offset:0
    ds_read_b128 v[152:155], v44 offset:1024
    ds_read_b128 v[156:159], v44 offset:16384
    ds_read_b128 v[160:163], v44 offset:17408
    ds_read_b128 v[164:167], v44 offset:32768
    ds_read_b128 v[168:171], v44 offset:33792
    ds_read_b128 v[172:175], v44 offset:49152
    ds_read_b128 v[176:179], v44 offset:50176
    ds_read_b128 v[180:183], v45 offset:0
    ds_read_b128 v[184:187], v45 offset:1024
    ds_read_b128 v[188:191], v45 offset:16384
    ds_read_b128 v[192:195], v45 offset:17408
    ds_read_b128 v[196:199], v45 offset:32768
    ds_read_b128 v[200:203], v45 offset:33792
    ds_read_b128 v[204:207], v45 offset:49152
    ds_read_b128 v[208:211], v45 offset:50176
    s_waitcnt lgkmcnt(14)
    v_pk_add_f32 v[116:117], v[116:117], v[148:149]
    v_pk_add_f32 v[118:119], v[118:119], v[150:151]
    v_pk_add_f32 v[120:121], v[120:121], v[152:153]
    v_pk_add_f32 v[122:123], v[122:123], v[154:155]
    s_waitcnt lgkmcnt(12)
    v_pk_add_f32 v[116:117], v[116:117], v[156:157]
    v_pk_add_f32 v[118:119], v[118:119], v[158:159]
    v_pk_add_f32 v[120:121], v[120:121], v[160:161]
    v_pk_add_f32 v[122:123], v[122:123], v[162:163]
    s_waitcnt lgkmcnt(10)
    v_pk_add_f32 v[116:117], v[116:117], v[164:165]
    v_pk_add_f32 v[118:119], v[118:119], v[166:167]
    v_pk_add_f32 v[120:121], v[120:121], v[168:169]
    v_pk_add_f32 v[122:123], v[122:123], v[170:171]
    s_waitcnt lgkmcnt(8)
    v_pk_add_f32 v[116:117], v[116:117], v[172:173]
    v_pk_add_f32 v[118:119], v[118:119], v[174:175]
    v_pk_add_f32 v[120:121], v[120:121], v[176:177]
    v_pk_add_f32 v[122:123], v[122:123], v[178:179]
    s_waitcnt lgkmcnt(6)
    v_pk_add_f32 v[116:117], v[116:117], v[180:181]
    v_pk_add_f32 v[118:119], v[118:119], v[182:183]
    v_pk_add_f32 v[120:121], v[120:121], v[184:185]
    v_pk_add_f32 v[122:123], v[122:123], v[186:187]
    s_waitcnt lgkmcnt(4)
    v_pk_add_f32 v[116:117], v[116:117], v[188:189]
    v_pk_add_f32 v[118:119], v[118:119], v[190:191]
    v_pk_add_f32 v[120:121], v[120:121], v[192:193]
    v_pk_add_f32 v[122:123], v[122:123], v[194:195]
    s_waitcnt lgkmcnt(2)
    v_pk_add_f32 v[116:117], v[116:117], v[196:197]
    v_pk_add_f32 v[118:119], v[118:119], v[198:199]
    v_pk_add_f32 v[120:121], v[120:121], v[200:201]
    v_pk_add_f32 v[122:123], v[122:123], v[202:203]
    s_waitcnt lgkmcnt(0)
    v_pk_add_f32 v[116:117], v[116:117], v[204:205]
    v_pk_add_f32 v[118:119], v[118:119], v[206:207]
    v_pk_add_f32 v[120:121], v[120:121], v[208:209]
    v_pk_add_f32 v[122:123], v[122:123], v[210:211]
    v_cvt_pk_bf16_f32 v36, v116, v117
    v_cvt_pk_bf16_f32 v37, v118, v119
    buffer_store_dwordx2 v[36:37], v2, s[28:31], s44 offen offset:0
    v_cvt_pk_bf16_f32 v38, v120, v121
    v_cvt_pk_bf16_f32 v39, v122, v123
    buffer_store_dwordx2 v[38:39], v2, s[28:31], s44 offen offset:16
    s_or_b32 s43, s2, s24
    s_cmp_lg_u32 s43, 0
    s_cbranch_scc1 parallel_sum__mha_block__swiglu_ffn__prompt_kernel_notag
    s_mov_b32 s43, 20987904
    v_mov_b32 v44, s84
    v_mov_b32 v45, 0
    s_mov_b64 exec, 1
    buffer_store_dword v44, v45, s[12:15], s43 offen sc0 sc1
    s_mov_b64 exec, -1
parallel_sum__mha_block__swiglu_ffn__prompt_kernel_notag:
parallel_sum__mha_block__swiglu_ffn__prompt_kernel_end:
    s_endpgm
parallel_sum__mha_block__swiglu_ffn__prompt_kernel_fb:
    s_waitcnt vmcnt(0)
    s_mov_b32 s40, 1
    s_add_u32 s36, s32, 4194304
    s_mov_b32 s44, 64
    v_mov_b32 v44, 0xff800000
parallel_sum__mha_block__swiglu_ffn__prompt_kernel_maxloop:
    buffer_load_dwordx4 v[12:15], v1, s[12:15], s36 offen sc0 sc1
    s_add_u32 s36, s36, 1024
    s_waitcnt vmcnt(0)
    v_mfma_f32_32x32x16_bf16 v[116:131], v[12:15], v[8:11], 0
    s_nop 11
    v_max3_f32 v44, v44, v116, v117
    v_max3_f32 v44, v44, v118, v119
    v_max3_f32 v44, v44, v120, v121
    v_max3_f32 v44, v44, v122, v123
    v_max3_f32 v44, v44, v124, v125
    v_max3_f32 v44, v44, v126, v127
    v_max3_f32 v44, v44, v128, v129
    v_max3_f32 v44, v44, v130, v131
    s_sub_u32 s44, s44, 1
    s_cmp_lg_u32 s44, 0
    s_cbranch_scc1 parallel_sum__mha_block__swiglu_ffn__prompt_kernel_maxloop
    s_mov_b32 s43, 0
    v_mov_b32 v46, v44
    v_mov_b32 v47, v44
    s_nop 1
    v_permlane32_swap_b32 v46, v47
    v_max_f32 v46, v46, v47
    v_sub_f32 v46, s43, v46
    v_mov_b32 v84, v46
    v_mov_b32 v85, v46
    v_mov_b32 v86, v46
    v_mov_b32 v87, v46
    v_mov_b32 v88, v46
    v_mov_b32 v89, v46
    v_mov_b32 v90, v46
    v_mov_b32 v91, v46
    v_mov_b32 v92, v46
    v_mov_b32 v93, v46
    v_mov_b32 v94, v46
    v_mov_b32 v95, v46
    v_mov_b32 v96, v46
    v_mov_b32 v97, v46
    v_mov_b32 v98, v46
    v_mov_b32 v99, v46
    s_barrier
    s_mov_b32 s37, s34
    s_mov_b32 s61, s35
    s_mov_b32 s41, 0
    s_add_u32 m0, s41, s56
    s_add_u32 s57, s41, s60
    buffer_load_dwordx4 v1, s[12:15], s37 offen sc0 sc1 lds
    s_mov_b32 m0, s57
    s_add_u32 s37, s37, 8192
    buffer_load_dwordx4 v1, s[12:15], s61 offen sc0 sc1 lds
    buffer_load_dwordx4 v1, s[12:15], s61 offen offset:1024 sc0 sc1 lds
    s_add_u32 s61, s61, 16384
    s_add_u32 s41, s41, 24576
    s_cmp_eq_u32 s41, 73728
    s_cselect_b32 s41, 0, s41
    s_add_u32 m0, s41, s56
    s_add_u32 s57, s41, s60
    buffer_load_dwordx4 v1, s[12:15], s37 offen sc0 sc1 lds
    s_mov_b32 m0, s57
    s_add_u32 s37, s37, 8192
    buffer_load_dwordx4 v1, s[12:15], s61 offen sc0 sc1 lds
    buffer_load_dwordx4 v1, s[12:15], s61 offen offset:1024 sc0 sc1 lds
    s_add_u32 s61, s61, 16384
    s_add_u32 s41, s41, 24576
    s_cmp_eq_u32 s41, 73728
    s_cselect_b32 s41, 0, s41
    s_branch parallel_sum__mha_block__swiglu_ffn__prompt_kernel_common
parallel_sum__mha_block__swiglu_ffn__prompt_kernel_h:
    v_and_b32 v46, 15, v0
    v_lshlrev_b32 v46, 2, v46
    s_lshr_b32 s43, s50, 1
    s_lshl_b32 s43, s43, 7
    s_add_u32 s43, s43, 20977664
    s_mov_b32 s59, 0x40000
parallel_sum__mha_block__swiglu_ffn__prompt_kernel_hp:
    buffer_load_dword v44, v46, s[12:15], s43 offen sc0 sc1
    s_waitcnt vmcnt(0)
    v_cmp_ne_u32 vcc, s84, v44
    s_cmp_eq_u64 vcc, 0
    s_cbranch_scc1 parallel_sum__mha_block__swiglu_ffn__prompt_kernel_hp_ok
    s_sleep 2
    s_sub_u32 s59, s59, 1
    s_cmp_lg_u32 s59, 0
    s_cbranch_scc1 parallel_sum__mha_block__swiglu_ffn__prompt_kernel_hp
parallel_sum__mha_block__swiglu_ffn__prompt_kernel_hp_ok:
    s_branch parallel_sum__mha_block__swiglu_ffn__prompt_kernel_h_ok
parallel_sum__mha_block__swiglu_ffn__prompt_kernel_sq:
    s_mov_b32 s59, 0x100000
parallel_sum__mha_block__swiglu_ffn__prompt_kernel_sq_l:
    s_sleep 1
    ds_read_b32 v51, v50
    s_waitcnt lgkmcnt(0)
    v_cmp_lt_u32 vcc, v51, v48
    s_cmp_eq_u64 vcc, 0
    s_cbranch_scc1 parallel_sum__mha_block__swiglu_ffn__prompt_kernel_sq_ok
    s_sub_u32 s59, s59, 1
    s_cmp_lg_u32 s59, 0
    s_cbranch_scc1 parallel_sum__mha_block__swiglu_ffn__prompt_kernel_sq_l
    s_branch parallel_sum__mha_block__swiglu_ffn__prompt_kernel_sq_ok
parallel_sum__mha_block__swiglu_ffn__prompt_kernel_last:
.section .rodata,"a"
.p2align 6
.amdhsa_kernel parallel_sum__mha_block__swiglu_ffn__prompt_kernel
  .amdhsa_next_free_vgpr 256
  .amdhsa_next_free_sgpr 100
  .amdhsa_accum_offset 256
  .amdhsa_group_segment_fixed_size 0
  .amdhsa_kernarg_size 80
  .amdhsa_user_sgpr_count 2
  .amdhsa_user_sgpr_kernarg_segment_ptr 1
  .amdhsa_system_sgpr_workgroup_id_x 1
.end_amdhsa_kernel
.text
```
